```python
import torch

def _softmax(x, axis=-1):
    return torch.softmax(x, dim=axis)

def _gelu(x):
    return torch.nn.functional.gelu(x, approximate='tanh')

def _silu(x):
    return torch.nn.functional.silu(x)

def _sigmoid(x):
    return torch.sigmoid(x)

def _layernorm(x, axis=-1, eps=1e-05):
    m = x.mean(dim=axis, keepdim=True)
    v = x.var(dim=axis, keepdim=True, unbiased=False)
    return (x - m) / torch.sqrt(v + eps)

def _scatter_add(tgt, idx, src, axis=0):
    return tgt.clone().index_add_(axis, idx, src)

def _segment_sum(src, seg, n):
    out = torch.zeros((n,) + src.shape[1:], dtype=src.dtype)
    return out.index_add_(0, seg, src)

def _pad(x, pw):
    flat = tuple((v for pair in reversed(pw) for v in pair))
    return torch.nn.functional.pad(x, flat)
kernel_name = 'adaLN_cond__mha_block__moe_arch_mod__prompt'

def setup_inputs():

    _w = lambda a: (lambda t: t.to(torch.bfloat16) if t.is_floating_point() else t)(torch.as_tensor(a))

    def _A_setup():
        B, S, D, H = (1, 2048, 512, 32)
        return {'x': _w((lambda *s: torch.randn(*s, dtype=torch.bfloat16) * 0.05)(B, S, D)), 'wqkv': _w((lambda *s: torch.randn(*s, dtype=torch.bfloat16) * 0.05)(D, 3 * D)), 'wo': _w((lambda *s: torch.randn(*s, dtype=torch.bfloat16) * 0.05)(D, D))}
    _A_in = _A_setup()

    def _B_setup():
        B, S, D, F, C = (1, 2048, 512, 1792, 2)
        return {'x': _w((lambda *s: torch.randn(*s, dtype=torch.bfloat16) * 0.05)(B, S, D)), 'w_r': _w((lambda *s: torch.randn(*s, dtype=torch.bfloat16) * 0.05)(D)), 'w_gate': _w((lambda *s: torch.randn(*s, dtype=torch.bfloat16) * 0.05)(D, F)), 'w_up': _w((lambda *s: torch.randn(*s, dtype=torch.bfloat16) * 0.05)(D, F)), 'w_down': _w((lambda *s: torch.randn(*s, dtype=torch.bfloat16) * 0.05)(F, D))}
    _B_in = _B_setup()
    return {'A_x': _A_in['x'], 'A_wqkv': _A_in['wqkv'], 'A_wo': _A_in['wo'], 'B_x': _B_in['x'], 'B_w_r': _B_in['w_r'], 'B_w_gate': _B_in['w_gate'], 'B_w_up': _B_in['w_up'], 'B_w_down': _B_in['w_down'], 'c': _w((lambda *s: torch.randn(*s, dtype=torch.bfloat16) * 0.1)(1, 512) * 8.0), 'w_mod': _w((lambda *s: torch.randn(*s, dtype=torch.bfloat16) * 0.1)(512, 6 * 512) * 512 ** (-0.5) * 8.0)}

def reference(A_x, A_wqkv, A_wo, B_x, B_w_r, B_w_gate, B_w_up, B_w_down, c, w_mod):

    def _A_ref(x, wqkv, wo):
        B, S, D = x.shape
        H = 32
        Dh = D // H
        qkv = (lambda x, *d: x.permute(*d))((x @ wqkv).reshape(B, S, 3, H, Dh), 2, 0, 3, 1, 4)
        q, k, v = (qkv[0], qkv[1], qkv[2])
        scores = torch.einsum('bhqd,bhkd->bhqk', q, k) * Dh ** (-0.5)
        p = _softmax(scores, axis=-1)
        o = torch.einsum('bhqk,bhkd->bhqd', p, v)
        return (lambda x, *d: x.permute(*d))(o, 0, 2, 1, 3).reshape(B, S, D) @ wo

    def _B_ref(x, w_r, w_gate, w_up, w_down):
        B, S, D = x.shape
        C = 2
        r = x @ w_r
        idx = torch.argsort(-r, axis=-1)[:, :C]
        idx_e = (lambda x, n, axis: torch.repeat_interleave(x, n, dim=axis))(idx.reshape(B, C, 1), D, axis=2)
        x_sel = (lambda x, i, axis: torch.take_along_dim(x, i, dim=axis))(x, idx_e, axis=1)
        g = _silu(x_sel @ w_gate)
        u = x_sel @ w_up
        y = g * u @ w_down
        r_sel = _sigmoid((lambda x, i, axis: torch.take_along_dim(x, i, dim=axis))(r, idx, axis=1))
        y = y * r_sel.reshape(B, C, 1)
        b_off = (torch.arange(B) * S).reshape(B, 1)
        flat_idx = (idx + b_off).reshape(B * C)
        zero = (x * 0.0).reshape(B * S, D)
        upd = _scatter_add(zero, flat_idx, y.reshape(B * C, D), axis=0)
        return x + upd.reshape(B, S, D)
    x = A_x
    mod = (_silu(c) @ w_mod).reshape(c.shape[0], 6, 1, -1)
    sa, ca, ga, sb, cb, gb = (mod[:, 0].clone(), mod[:, 1].clone(), mod[:, 2].clone(), mod[:, 3].clone(), mod[:, 4].clone(), mod[:, 5].clone())
    h = _layernorm(x, axis=-1) * (1 + ca) + sa
    x = x + ga * _A_ref(h, A_wqkv, A_wo)
    h = _layernorm(x, axis=-1) * (1 + cb) + sb
    x = x + gb * _B_ref(h, B_w_r, B_w_gate, B_w_up, B_w_down)
    return x
```

```asm
; @launch grid=(256,1,1) block=(512,1,1) lds=163840
.amdgcn_target "amdgcn-amd-amdhsa--gfx950"
.text
.globl adaLN_cond__mha_block__moe_arch_mod__prompt_kernel
.p2align 8
.type adaLN_cond__mha_block__moe_arch_mod__prompt_kernel,@function
adaLN_cond__mha_block__moe_arch_mod__prompt_kernel:
  s_cmp_ge_u32 s2, 256
  s_cbranch_scc1 main_end
  s_setprio 3
  s_load_dwordx2 s[4:5], s[0:1], 96
  s_load_dwordx4 s[44:47], s[0:1], 64
  s_load_dwordx2 s[6:7], s[0:1], 0
  s_load_dwordx4 s[8:11], s[0:1], 8
  s_load_dwordx8 s[52:59], s[0:1], 32
  s_load_dwordx2 s[50:51], s[0:1], 80
  v_lshrrev_b32 v1, 6, v0
  v_and_b32 v2, 63, v0
  s_and_b32 s31, s2, 1
  s_lshl_b32 s31, s31, 2
  v_readfirstlane_b32 s32, v1
  s_bfe_u32 s20, s2, 0x20003
  s_add_u32 s31, s31, s20
  s_and_b32 s30, s2, 6
  s_lshl_b32 s30, s30, 2
  s_lshr_b32 s20, s2, 5
  s_add_u32 s30, s30, s20
  s_lshl_b32 s33, s20, 1
  v_lshlrev_b32 v9, 4, v2
  v_lshrrev_b32 v17, 3, v2
  v_and_b32 v16, 6, v17
  v_xor_b32 v16, v16, v2
  v_and_b32 v16, 7, v16
  v_lshlrev_b32 v200, 10, v17
  v_lshl_add_u32 v200, v16, 4, v200
  v_add_u32 v201, 7168, v200
  v_add_u32 v202, 14336, v200
  v_add_u32 v203, 21504, v200
  v_lshrrev_b32 v16, 1, v2
  v_bfe_u32 v17, v2, 4, 1
  v_lshlrev_b32 v17, 2, v17
  v_xor_b32 v16, v16, v17
  v_mul_u32_u24 v255, 6144, v16
  v_and_b32 v17, 1, v2
  v_lshl_add_u32 v255, v17, 4, v255
  s_lshl_b32 s28, s31, 18
  s_lshl_b32 s21, s32, 15
  s_add_u32 s28, s28, s21
  s_lshl_b32 s29, s33, 6
  s_mul_i32 s49, s32, 12288
  s_add_u32 s49, s49, 49152
  v_lshrrev_b32 v3, 1, v2
  v_lshl_add_u32 v3, v1, 6, v3
  v_and_b32 v6, 1, v0
  v_bfe_u32 v22, v2, 1, 2
  v_mul_u32_u24 v22, 3072, v22
  v_lshrrev_b32 v17, 3, v2
  v_lshl_add_u32 v22, v17, 5, v22
  v_lshl_add_u32 v22, v6, 4, v22
  v_mul_u32_u24 v23, 16768, v17
  v_and_b32 v17, 7, v2
  v_lshl_add_u32 v23, v17, 4, v23
  s_and_b32 s36, s2, 7
  s_lshl_b32 s36, s36, 4
  s_lshr_b32 s20, s2, 4
  s_add_u32 s36, s36, s20
  s_bfe_u32 s37, s2, 0x10003
  v_lshlrev_b32 v19, 3, v2
  s_lshl_b32 s39, s2, 3
  s_add_u32 s39, s39, s32
  s_and_b32 s62, s2, 7
  s_lshl_b32 s62, s62, 3
  s_bfe_u32 s23, s2, 0x30003
  s_add_u32 s62, s62, s23
  s_waitcnt lgkmcnt(0)
  s_load_dword s48, s[4:5], 0
  s_mov_b32 s24, s6
  s_mov_b32 s25, s7
  s_mov_b32 s26, 2097152
  s_mov_b32 s27, 0x20000
  s_mov_b32 s16, s4
  s_mov_b32 s17, s5
  s_mov_b32 s18, 268435456
  s_mov_b32 s19, 0x20000
  s_mov_b32 s12, s8
  s_mov_b32 s13, s9
  s_mov_b32 s14, 1572864
  s_mov_b32 s15, 0x20000
  s_cmp_lg_u32 s32, 0
  s_cbranch_scc1 main_w0a
  s_lshr_b32 s21, s2, 6
  s_lshl_b32 s22, s21, 8
  v_lshl_add_u32 v16, v2, 2, s22
  global_load_dword v232, v16, s[44:45]
  s_mov_b32 s40, s46
  s_mov_b32 s41, s47
  s_mov_b32 s42, 3145728
  s_mov_b32 s43, 0x20000
  s_mul_i32 s22, s21, 786432
  s_lshl_b32 s23, s62, 5
  s_add_u32 s22, s22, s23
  s_mov_b32 m0, 147456
  s_nop 0
  buffer_load_dwordx4 v255, s[40:43], s22 offen lds
  s_mov_b32 m0, 148480
  s_add_u32 s22, s22, 196608
  buffer_load_dwordx4 v255, s[40:43], s22 offen lds
  s_mov_b32 m0, 149504
  s_add_u32 s22, s22, 196608
  buffer_load_dwordx4 v255, s[40:43], s22 offen lds
  s_mov_b32 m0, 150528
  s_add_u32 s22, s22, 196608
  buffer_load_dwordx4 v255, s[40:43], s22 offen lds
  s_branch main_w0i
main_w0a:
  s_cmp_eq_u32 s32, 7
  s_cbranch_scc1 main_w7
  s_mul_i32 s20, s36, 12288
  s_mul_i32 s21, s37, 1536
  s_add_u32 s20, s20, s21
  s_lshl_b32 s21, s32, 8
  s_add_u32 s20, s20, s21
  s_sub_u32 s20, s20, 256
  buffer_load_dwordx4 v[160:163], v22, s[12:15], s20 offen
  s_branch main_w0i
main_w7:
  s_lshl_b32 s20, s2, 8
  v_lshlrev_b32 v16, 21, v2
  s_mov_b64 exec, 0x3f
  buffer_load_dword v160, v16, s[16:19], s20 offen
  s_mov_b64 exec, 1
  v_mov_b32 v16, s20
  global_load_dword v161, v16, s[10:11]
  global_load_dword v162, v16, s[54:55]
  global_load_dword v163, v16, s[56:57]
  global_load_dword v164, v16, s[58:59]
  global_load_dword v165, v16, s[50:51]
  s_mov_b64 exec, -1
main_w0i:
  s_lshl_b32 s22, s39, 10
  buffer_load_dwordx4 v[204:207], v9, s[24:27], s22 offen
  v_lshlrev_b32 v25, 4, v0
  v_lshrrev_b32 v7, 4, v2
  v_and_b32 v8, 15, v2
  v_lshrrev_b32 v14, 4, v2
  v_bfe_u32 v12, v2, 2, 2
  v_lshlrev_b32 v12, 5, v12
  v_and_b32 v15, 1, v14
  v_lshlrev_b32 v15, 7, v15
  v_xor_b32 v12, v12, v15
  v_lshl_add_u32 v12, v14, 8, v12
  v_and_b32 v15, 3, v2
  v_lshl_add_u32 v12, v15, 3, v12
  v_xor_b32 v13, 0x80, v12
  s_lshl_b32 s21, s33, 10
  v_lshlrev_b32 v10, 5, v3
  v_subrev_u32 v10, s21, v10
  v_bfe_u32 v11, v3, 3, 1
  v_lshlrev_b32 v11, 7, v11
  v_xor_b32 v10, v10, v11
  v_lshl_add_u32 v10, v6, 4, v10
  v_and_b32 v10, 0x3fff, v10
  v_xor_b32 v11, 1024, v10
  s_lshl_b32 s20, s32, 11
  s_sub_u32 s20, s20, s21
  s_and_b32 s20, s20, 0x3fff
  v_add_u32 v26, s20, v12
  v_add_u32 v27, s20, v13
  s_lshr_b32 s20, s20, 4
  s_add_u32 s20, s20, 151552
  v_lshl_add_u32 v30, v7, 4, s20
  s_lshl_b32 s21, s32, 12
  s_add_u32 s21, s21, 131072
  v_add_u32 v14, s21, v12
  v_add_u32 v15, s21, v13
  v_and_b32 v16, 6, v8
  v_xor_b32 v16, v16, v7
  v_lshlrev_b32 v16, 4, v16
  v_and_b32 v17, 7, v8
  v_lshl_add_u32 v16, v17, 7, v16
  v_lshrrev_b32 v17, 3, v8
  v_lshl_add_u32 v16, v17, 10, v16
  v_xor_b32 v17, 64, v16
  v_add_u32 v254, s49, v16
  v_add_u32 v255, s49, v17
  v_and_b32 v24, 31, v2
  v_lshlrev_b32 v24, 4, v24
  s_lshr_b32 s63, s28, 6
  s_add_u32 s63, s63, 65536
  s_lshr_b32 s41, s30, 2
  s_lshl_b32 s20, s31, 3
  s_add_u32 s41, s41, s20
  s_and_b32 s42, s30, 3
  v_and_b32 v29, 1, v2
  v_lshlrev_b32 v29, 4, v29
  v_lshrrev_b32 v28, 1, v2
  v_lshl_add_u32 v1, v28, 10, v29
  s_lshl_b32 s20, s42, 8
  s_lshl_b32 s21, s32, 5
  s_add_u32 s21, s21, s20
  v_add_u32 v1, s21, v1
  v_bfe_u32 v16, v2, 4, 1
  v_lshlrev_b32 v17, 2, v16
  v_xor_b32 v28, v28, v17
  v_lshrrev_b32 v5, 5, v2
  v_lshlrev_b32 v5, 9, v5
  v_lshl_add_u32 v5, v16, 7, v5
  v_bfe_u32 v16, v2, 2, 2
  v_lshl_add_u32 v5, v16, 5, v5
  v_and_b32 v16, 3, v2
  v_lshl_add_u32 v5, v16, 3, v5
  s_lshl_b32 s21, s32, 12
  s_add_u32 s21, s21, 131072
  v_add_u32 v5, s21, v5
  v_lshrrev_b32 v4, 4, v0
  v_lshlrev_b32 v4, 10, v4
  v_lshl_add_u32 v4, v8, 4, v4
  s_lshl_b32 s21, s41, 15
  s_add_u32 s20, s20, s21
  v_add_u32 v4, s20, v4
  s_lshl_b32 s20, s30, 13
  s_lshl_b32 s21, s32, 10
  s_add_u32 s40, s20, s21
  s_add_u32 s40, s40, 1048576
  s_cmp_lg_u32 s32, 0
  s_cbranch_scc1 main_w0j
  v_add_u32 v20, 147456, v12
  v_add_u32 v21, 147456, v13
  s_waitcnt vmcnt(5)
  v_lshlrev_b32 v233, 16, v232
  v_and_b32 v234, 0xffff0000, v232
  v_mul_f32 v16, 0xbfb8aa3b, v233
  v_exp_f32 v16, v16
  s_nop 0
  v_add_f32 v16, 1.0, v16
  v_rcp_f32 v16, v16
  s_nop 0
  v_mul_f32 v233, v233, v16
  v_mul_f32 v16, 0xbfb8aa3b, v234
  v_exp_f32 v16, v16
  s_nop 0
  v_add_f32 v16, 1.0, v16
  v_rcp_f32 v16, v16
  s_nop 0
  v_mul_f32 v234, v234, v16
  v_cvt_pk_bf16_f32 v232, v233, v234
  v_lshlrev_b32 v16, 2, v2
  v_add_u32 v16, 152576, v16
  ds_write_b32 v16, v232
  v_and_b32 v17, 48, v2
  v_add_u32 v17, 152576, v17
  ds_read_b128 v[236:239], v17 offset:0
  ds_read_b128 v[240:243], v17 offset:64
  ds_read_b128 v[244:247], v17 offset:128
  ds_read_b128 v[248:251], v17 offset:192
  s_lshr_b32 s38, s2, 6
  s_lshl_b32 s38, s38, 13
  s_lshl_b32 s22, s62, 7
  s_add_u32 s38, s38, s22
  s_add_u32 s38, s38, 4096
  s_waitcnt vmcnt(0)
  ds_read_b64_tr_b16 v[216:217], v20 offset:0
  ds_read_b64_tr_b16 v[218:219], v21 offset:0
  ds_read_b64_tr_b16 v[220:221], v20 offset:1024
  ds_read_b64_tr_b16 v[222:223], v21 offset:1024
  ds_read_b64_tr_b16 v[224:225], v20 offset:2048
  ds_read_b64_tr_b16 v[226:227], v21 offset:2048
  ds_read_b64_tr_b16 v[228:229], v20 offset:3072
  ds_read_b64_tr_b16 v[230:231], v21 offset:3072
  s_waitcnt lgkmcnt(0)
  s_add_u32 s22, s48, 1
  v_mfma_f32_16x16x32_bf16 v[232:235], v[236:239], v[216:219], 0
  v_mfma_f32_16x16x32_bf16 v[232:235], v[240:243], v[220:223], v[232:235]
  v_mfma_f32_16x16x32_bf16 v[232:235], v[244:247], v[224:227], v[232:235]
  v_mfma_f32_16x16x32_bf16 v[232:235], v[248:251], v[228:231], v[232:235]
  s_nop 7
  v_mov_b32 v184, v232
  v_mov_b32 v185, s22
  s_branch main_w0b
main_w0j:
  s_waitcnt vmcnt(0)
  s_cmp_eq_u32 s32, 7
  s_cbranch_scc1 main_w0b
  s_mul_i32 s20, s37, 6
  s_add_u32 s20, s20, s32
  s_mul_i32 s20, s20, 134144
  s_lshl_b32 s21, s36, 7
  s_add_u32 s20, s20, s21
  s_add_u32 s20, s20, 1963008
  buffer_store_dwordx4 v[160:163], v23, s[16:19], s20 offen sc1
main_w0b:
  s_barrier
  s_add_u32 s20, s28, s29
  s_mov_b32 m0, s49
  s_add_u32 s29, s29, 128
  buffer_load_dwordx4 v200, s[24:27], s20 offen offset:0 lds
  buffer_load_dwordx4 v201, s[24:27], s20 offen offset:1024 lds
  buffer_load_dwordx4 v202, s[24:27], s20 offen offset:2048 lds
  buffer_load_dwordx4 v203, s[24:27], s20 offen offset:3072 lds
  s_and_b32 s29, s29, 0x3ff
  s_waitcnt lgkmcnt(0)
  s_add_u32 s48, s48, 1
  v_lshlrev_b32 v208, 16, v204
  v_and_b32 v209, 0xffff0000, v204
  v_lshlrev_b32 v210, 16, v205
  v_and_b32 v211, 0xffff0000, v205
  v_lshlrev_b32 v212, 16, v206
  v_and_b32 v213, 0xffff0000, v206
  v_lshlrev_b32 v214, 16, v207
  v_and_b32 v215, 0xffff0000, v207
  v_add_f32 v216, v208, v209
  v_add_f32 v216, v216, v210
  v_add_f32 v216, v216, v211
  v_add_f32 v216, v216, v212
  v_add_f32 v216, v216, v213
  v_add_f32 v216, v216, v214
  v_add_f32 v216, v216, v215
  s_nop 1
  v_add_f32_dpp v216, v216, v216 row_ror:8 row_mask:0xf bank_mask:0xf
  s_nop 1
  v_add_f32_dpp v216, v216, v216 row_ror:4 row_mask:0xf bank_mask:0xf
  s_nop 1
  v_add_f32_dpp v216, v216, v216 row_ror:2 row_mask:0xf bank_mask:0xf
  s_nop 1
  v_add_f32_dpp v216, v216, v216 row_ror:1 row_mask:0xf bank_mask:0xf
  s_nop 1
  v_mov_b32 v217, v216
  s_nop 1
  v_permlane16_swap_b32 v217, v216
  s_nop 1
  v_add_f32 v216, v216, v217
  v_mov_b32 v217, v216
  s_nop 1
  v_permlane32_swap_b32 v217, v216
  s_nop 1
  v_add_f32 v216, v216, v217
  v_mul_f32 v216, 0x3b000000, v216
  v_sub_f32 v217, v208, v216
  v_mul_f32 v218, v217, v217
  v_sub_f32 v217, v209, v216
  v_fmac_f32 v218, v217, v217
  v_sub_f32 v217, v210, v216
  v_fmac_f32 v218, v217, v217
  v_sub_f32 v217, v211, v216
  v_fmac_f32 v218, v217, v217
  v_sub_f32 v217, v212, v216
  v_fmac_f32 v218, v217, v217
  v_sub_f32 v217, v213, v216
  v_fmac_f32 v218, v217, v217
  v_sub_f32 v217, v214, v216
  v_fmac_f32 v218, v217, v217
  v_sub_f32 v217, v215, v216
  v_fmac_f32 v218, v217, v217
  s_nop 1
  v_add_f32_dpp v218, v218, v218 row_ror:8 row_mask:0xf bank_mask:0xf
  s_nop 1
  v_add_f32_dpp v218, v218, v218 row_ror:4 row_mask:0xf bank_mask:0xf
  s_nop 1
  v_add_f32_dpp v218, v218, v218 row_ror:2 row_mask:0xf bank_mask:0xf
  s_nop 1
  v_add_f32_dpp v218, v218, v218 row_ror:1 row_mask:0xf bank_mask:0xf
  s_nop 1
  v_mov_b32 v217, v218
  s_nop 1
  v_permlane16_swap_b32 v217, v218
  s_nop 1
  v_add_f32 v218, v218, v217
  v_mov_b32 v217, v218
  s_nop 1
  v_permlane32_swap_b32 v217, v218
  s_nop 1
  v_add_f32 v218, v218, v217
  v_mul_f32 v217, 0x3b000000, v218
  v_cvt_pk_bf16_f32 v218, v216, v217
  v_lshlrev_b32 v216, 16, v218
  v_and_b32 v217, 0xffff0000, v218
  v_add_f32 v217, 0x3727c5ac, v217
  v_cvt_pk_bf16_f32 v217, v217, v217
  v_and_b32 v217, 0xffff0000, v217
  v_sqrt_f32 v217, v217
  s_lshl_b32 s21, s39, 4
  v_cvt_pk_bf16_f32 v217, v217, v217
  v_and_b32 v217, 0xffff0000, v217
  v_rcp_f32 v217, v217
  v_mov_b32 v218, s48
  v_mov_b32 v219, s48
  s_add_u32 s21, s21, 65536
  v_mov_b32 v16, 0
  s_mov_b64 exec, 1
  buffer_store_dwordx4 v[216:219], v16, s[16:19], s21 offen sc1
  s_mov_b64 exec, -1
  s_waitcnt vmcnt(5)
  s_barrier
  s_cmp_lg_u32 s32, 0
  s_cbranch_scc1 main_w0c
  s_mov_b64 exec, 0xffff
  buffer_store_dwordx2 v[184:185], v19, s[16:19], s38 offen sc1
  s_mov_b64 exec, -1
main_w0c:
  s_add_u32 s20, s28, s29
  s_add_u32 s21, s49, 4096
  s_mov_b32 m0, s21
  s_add_u32 s29, s29, 128
  buffer_load_dwordx4 v200, s[24:27], s20 offen offset:0 lds
  buffer_load_dwordx4 v201, s[24:27], s20 offen offset:1024 lds
  buffer_load_dwordx4 v202, s[24:27], s20 offen offset:2048 lds
  buffer_load_dwordx4 v203, s[24:27], s20 offen offset:3072 lds
  s_and_b32 s29, s29, 0x3ff
  s_add_u32 s20, s28, s29
  s_add_u32 s21, s49, 8192
  s_mov_b32 m0, s21
  s_add_u32 s29, s29, 128
  buffer_load_dwordx4 v200, s[24:27], s20 offen offset:0 lds
  buffer_load_dwordx4 v201, s[24:27], s20 offen offset:1024 lds
  buffer_load_dwordx4 v202, s[24:27], s20 offen offset:2048 lds
  buffer_load_dwordx4 v203, s[24:27], s20 offen offset:3072 lds
  s_and_b32 s29, s29, 0x3ff
  s_setprio 0
  s_waitcnt vmcnt(9)
  ds_read_b128 v[32:35], v254 offset:0
  ds_read_b128 v[96:99], v254 offset:2048
  ds_read_b128 v[36:39], v255 offset:0
  ds_read_b128 v[100:103], v255 offset:2048
  s_waitcnt lgkmcnt(0)
  s_add_u32 s20, s28, s29
  s_mov_b32 m0, s49
  s_add_u32 s29, s29, 128
  buffer_load_dwordx4 v200, s[24:27], s20 offen offset:0 lds
  buffer_load_dwordx4 v201, s[24:27], s20 offen offset:1024 lds
  buffer_load_dwordx4 v202, s[24:27], s20 offen offset:2048 lds
  buffer_load_dwordx4 v203, s[24:27], s20 offen offset:3072 lds
  s_and_b32 s29, s29, 0x3ff
  s_waitcnt vmcnt(8)
  s_setprio 3
  s_mov_b32 s22, 4096
  buffer_load_dwordx4 v[184:187], v25, s[16:19], s22 offen sc1
  s_mov_b32 s22, 12288
  buffer_load_dwordx4 v[188:191], v25, s[16:19], s22 offen sc1
  s_mov_b32 s22, 20480
  buffer_load_dwordx4 v[192:195], v25, s[16:19], s22 offen sc1
  s_mov_b32 s22, 28672
  buffer_load_dwordx4 v[196:199], v25, s[16:19], s22 offen sc1
  ds_read_b128 v[40:43], v254 offset:4096
  ds_read_b128 v[104:107], v254 offset:6144
  ds_read_b128 v[44:47], v255 offset:4096
  ds_read_b128 v[108:111], v255 offset:6144
  s_waitcnt vmcnt(8)
  ds_read_b128 v[48:51], v254 offset:8192
  ds_read_b128 v[112:115], v254 offset:10240
  ds_read_b128 v[52:55], v255 offset:8192
  ds_read_b128 v[116:119], v255 offset:10240
  s_waitcnt vmcnt(0)
  v_cmp_ne_u32 vcc, s48, v185
  v_cmp_ne_u32 s[20:21], s48, v187
  s_or_b64 vcc, vcc, s[20:21]
  v_cmp_ne_u32 s[20:21], s48, v189
  s_or_b64 vcc, vcc, s[20:21]
  v_cmp_ne_u32 s[20:21], s48, v191
  s_or_b64 vcc, vcc, s[20:21]
  v_cmp_ne_u32 s[20:21], s48, v193
  s_or_b64 vcc, vcc, s[20:21]
  v_cmp_ne_u32 s[20:21], s48, v195
  s_or_b64 vcc, vcc, s[20:21]
  v_cmp_ne_u32 s[20:21], s48, v197
  s_or_b64 vcc, vcc, s[20:21]
  v_cmp_ne_u32 s[20:21], s48, v199
  s_or_b64 vcc, vcc, s[20:21]
  s_cmp_eq_u64 vcc, 0
  s_cbranch_scc1 main_gok
  s_mov_b32 s60, 50000
Lm_1:
  s_mov_b32 s22, 4096
  buffer_load_dwordx4 v[184:187], v25, s[16:19], s22 offen sc1
  s_mov_b32 s22, 12288
  buffer_load_dwordx4 v[188:191], v25, s[16:19], s22 offen sc1
  s_mov_b32 s22, 20480
  buffer_load_dwordx4 v[192:195], v25, s[16:19], s22 offen sc1
  s_mov_b32 s22, 28672
  buffer_load_dwordx4 v[196:199], v25, s[16:19], s22 offen sc1
  s_waitcnt vmcnt(0)
  v_cmp_ne_u32 vcc, s48, v185
  v_cmp_ne_u32 s[20:21], s48, v187
  s_or_b64 vcc, vcc, s[20:21]
  v_cmp_ne_u32 s[20:21], s48, v189
  s_or_b64 vcc, vcc, s[20:21]
  v_cmp_ne_u32 s[20:21], s48, v191
  s_or_b64 vcc, vcc, s[20:21]
  v_cmp_ne_u32 s[20:21], s48, v193
  s_or_b64 vcc, vcc, s[20:21]
  v_cmp_ne_u32 s[20:21], s48, v195
  s_or_b64 vcc, vcc, s[20:21]
  v_cmp_ne_u32 s[20:21], s48, v197
  s_or_b64 vcc, vcc, s[20:21]
  v_cmp_ne_u32 s[20:21], s48, v199
  s_or_b64 vcc, vcc, s[20:21]
  s_cmp_eq_u64 vcc, 0
  s_cbranch_scc1 Lmd_2
  s_sub_u32 s60, s60, 1
  s_sleep 4
  s_cmp_lg_u32 s60, 0
  s_cbranch_scc1 Lm_1
Lmd_2:
main_gok:
  s_mul_i32 s20, s30, 16768
  s_lshl_b32 s21, s32, 11
  s_add_u32 s20, s20, s21
  s_add_u32 s20, s20, 2097152
  s_add_u32 s21, s20, 0
  buffer_load_dwordx4 v[160:163], v9, s[16:19], s21 offen offset:0 sc1
  buffer_load_dwordx4 v[172:175], v9, s[16:19], s21 offen offset:1024 sc1
  s_add_u32 s21, s20, 1073152
  buffer_load_dwordx4 v[168:171], v9, s[16:19], s21 offen offset:0 sc1
  buffer_load_dwordx4 v[180:183], v9, s[16:19], s21 offen offset:1024 sc1
  s_add_u32 s21, s20, 536576
  buffer_load_dwordx4 v[164:167], v9, s[16:19], s21 offen offset:0 sc1
  buffer_load_dwordx4 v[176:179], v9, s[16:19], s21 offen offset:1024 sc1
  s_setprio 0
  ds_read_b128 v[56:59], v254 offset:0
  ds_read_b128 v[120:123], v254 offset:2048
  ds_read_b128 v[60:63], v255 offset:0
  ds_read_b128 v[124:127], v255 offset:2048
  v_add_f32 v184, v184, v188
  v_add_f32 v192, v192, v196
  v_add_f32 v184, v184, v192
  v_add_f32 v186, v186, v190
  v_add_f32 v194, v194, v198
  v_add_f32 v186, v186, v194
  v_cvt_pk_bf16_f32 v188, v184, v186
  s_cmp_gt_u32 s32, 3
  s_cbranch_scc1 main_gca
  s_lshl_b32 s21, s33, 6
  v_lshlrev_b32 v16, 2, v0
  v_subrev_u32 v16, s21, v16
  v_and_b32 v16, 0x3ff, v16
  v_add_u32 v16, 151552, v16
  ds_write_b32 v16, v188
  s_branch main_gdn
main_gca:
  v_lshlrev_b32 v184, 16, v188
  v_and_b32 v185, 0xffff0000, v188
  v_add_f32 v184, 1.0, v184
  v_add_f32 v185, 1.0, v185
  v_cvt_pk_bf16_f32 v188, v184, v185
  v_lshlrev_b32 v184, 16, v188
  v_and_b32 v185, 0xffff0000, v188
  v_lshlrev_b32 v16, 3, v0
  v_add_u32 v16, 150784, v16
  ds_write_b64 v16, v[184:185]
main_gdn:
  v_lshlrev_b32 v16, 2, v3
  v_add_u32 v16, 152832, v16
  v_xor_b32 v17, 128, v16
  s_waitcnt lgkmcnt(0)
  s_add_u32 s20, s28, s29
  s_add_u32 s21, s49, 4096
  s_mov_b32 m0, s21
  s_add_u32 s29, s29, 128
  buffer_load_dwordx4 v200, s[24:27], s20 offen offset:0 lds
  buffer_load_dwordx4 v201, s[24:27], s20 offen offset:1024 lds
  buffer_load_dwordx4 v202, s[24:27], s20 offen offset:2048 lds
  buffer_load_dwordx4 v203, s[24:27], s20 offen offset:3072 lds
  s_and_b32 s29, s29, 0x3ff
  s_waitcnt vmcnt(6)
  s_lshl_b32 s20, s31, 7
  s_add_u32 s20, s20, s40
  s_xor_b32 s21, s48, 0x80000000
  v_mov_b32 v18, s21
  v_lshlrev_b32 v19, 2, v2
  s_mov_b32 exec_hi, 0
  buffer_store_dword v18, v19, s[16:19], s20 offen sc1
  s_mov_b64 exec, -1
  ds_write_b128 v10, v[160:163] offset:32768
  ds_write_b128 v11, v[172:175] offset:32768
  ds_write_b128 v10, v[168:171] offset:16384
  ds_write_b128 v11, v[180:183] offset:16384
  ds_read_b64_tr_b16 v[236:237], v26 offset:32768
  ds_read_b64_tr_b16 v[238:239], v27 offset:32768
  ds_read_b64_tr_b16 v[240:241], v26 offset:16384
  ds_read_b64_tr_b16 v[242:243], v27 offset:16384
  ds_read_b64_tr_b16 v[244:245], v26 offset:33792
  ds_read_b64_tr_b16 v[246:247], v27 offset:33792
  ds_read_b64_tr_b16 v[248:249], v26 offset:17408
  ds_read_b64_tr_b16 v[250:251], v27 offset:17408
  v_mov_b32 v204, 0x3f803f80
  v_mov_b32 v205, 0x3f803f80
  v_mov_b32 v206, 0x3f803f80
  v_mov_b32 v207, 0x3f803f80
  s_mov_b32 s22, 0xffff0000
  v_lshlrev_b32 v80, 16, v160
  v_and_b32 v81, s22, v160
  v_lshlrev_b32 v82, 16, v161
  v_and_b32 v83, s22, v161
  v_lshlrev_b32 v84, 16, v162
  v_and_b32 v85, s22, v162
  v_lshlrev_b32 v86, 16, v163
  v_and_b32 v87, s22, v163
  v_lshlrev_b32 v88, 16, v172
  v_and_b32 v89, s22, v172
  v_lshlrev_b32 v90, 16, v173
  v_and_b32 v91, s22, v173
  v_lshlrev_b32 v92, 16, v174
  v_and_b32 v93, s22, v174
  v_lshlrev_b32 v94, 16, v175
  v_and_b32 v95, s22, v175
  v_lshlrev_b32 v128, 16, v168
  v_and_b32 v129, s22, v168
  v_lshlrev_b32 v130, 16, v169
  v_and_b32 v131, s22, v169
  v_lshlrev_b32 v132, 16, v170
  v_and_b32 v133, s22, v170
  v_lshlrev_b32 v134, 16, v171
  v_and_b32 v135, s22, v171
  v_lshlrev_b32 v136, 16, v180
  v_and_b32 v137, s22, v180
  v_lshlrev_b32 v138, 16, v181
  v_and_b32 v139, s22, v181
  v_lshlrev_b32 v140, 16, v182
  v_and_b32 v141, s22, v182
  v_lshlrev_b32 v142, 16, v183
  v_and_b32 v143, s22, v183
  s_waitcnt vmcnt(5)
  v_lshlrev_b32 v64, 16, v164
  v_and_b32 v65, s22, v164
  v_lshlrev_b32 v66, 16, v165
  v_and_b32 v67, s22, v165
  v_lshlrev_b32 v68, 16, v166
  v_and_b32 v69, s22, v166
  v_lshlrev_b32 v70, 16, v167
  v_and_b32 v71, s22, v167
  v_lshlrev_b32 v72, 16, v176
  v_and_b32 v73, s22, v176
  v_lshlrev_b32 v74, 16, v177
  v_and_b32 v75, s22, v177
  v_lshlrev_b32 v76, 16, v178
  v_and_b32 v77, s22, v178
  v_lshlrev_b32 v78, 16, v179
  v_and_b32 v79, s22, v179
  s_waitcnt lgkmcnt(0)
  s_barrier
  ds_read_b32 v188, v16
  ds_read_b32 v189, v17
  ds_read_b128 v[192:195], v30 offset:0
  ds_read_b128 v[196:199], v30 offset:64
  s_mul_i32 s21, s32, 320
  s_add_u32 s21, s21, 154880
  v_lshl_add_u32 v30, v7, 4, s21
  v_lshl_add_u32 v31, v8, 3, s21
  s_waitcnt lgkmcnt(2)
  v_pk_mul_f32 v[64:65], v[64:65], v[188:189] op_sel_hi:[1,0]
  v_pk_mul_f32 v[66:67], v[66:67], v[188:189] op_sel_hi:[1,0]
  v_pk_mul_f32 v[68:69], v[68:69], v[188:189] op_sel_hi:[1,0]
  v_pk_mul_f32 v[70:71], v[70:71], v[188:189] op_sel_hi:[1,0]
  v_cvt_pk_bf16_f32 v208, v64, v65
  v_cvt_pk_bf16_f32 v209, v66, v67
  v_cvt_pk_bf16_f32 v210, v68, v69
  v_cvt_pk_bf16_f32 v211, v70, v71
  ds_write_b128 v10, v[208:211] offset:0
  v_pk_mul_f32 v[72:73], v[72:73], v[188:189] op_sel:[0,1] op_sel_hi:[1,1]
  v_pk_mul_f32 v[74:75], v[74:75], v[188:189] op_sel:[0,1] op_sel_hi:[1,1]
  v_pk_mul_f32 v[76:77], v[76:77], v[188:189] op_sel:[0,1] op_sel_hi:[1,1]
  v_pk_mul_f32 v[78:79], v[78:79], v[188:189] op_sel:[0,1] op_sel_hi:[1,1]
  v_cvt_pk_bf16_f32 v212, v72, v73
  v_cvt_pk_bf16_f32 v213, v74, v75
  v_cvt_pk_bf16_f32 v214, v76, v77
  v_cvt_pk_bf16_f32 v215, v78, v79
  ds_write_b128 v11, v[212:215] offset:0
  ds_read_b64_tr_b16 v[64:65], v26 offset:0
  ds_read_b64_tr_b16 v[66:67], v27 offset:0
  ds_read_b64_tr_b16 v[68:69], v26 offset:1024
  ds_read_b64_tr_b16 v[70:71], v27 offset:1024
  s_waitcnt lgkmcnt(6)
  v_mfma_f32_16x16x32_bf16 v[216:219], v[236:239], v[192:195], 0
  v_mfma_f32_16x16x32_bf16 v[220:223], v[192:195], v[240:243], 0
  v_mfma_f32_16x16x32_bf16 v[216:219], v[244:247], v[196:199], v[216:219]
  v_mfma_f32_16x16x32_bf16 v[220:223], v[196:199], v[248:251], v[220:223]
  v_pk_mul_f32 v[128:129], v[128:129], v[188:189] op_sel_hi:[1,0]
  v_pk_mul_f32 v[130:131], v[130:131], v[188:189] op_sel_hi:[1,0]
  v_pk_mul_f32 v[132:133], v[132:133], v[188:189] op_sel_hi:[1,0]
  v_pk_mul_f32 v[134:135], v[134:135], v[188:189] op_sel_hi:[1,0]
  v_cvt_pk_bf16_f32 v208, v128, v129
  v_cvt_pk_bf16_f32 v209, v130, v131
  v_cvt_pk_bf16_f32 v210, v132, v133
  v_cvt_pk_bf16_f32 v211, v134, v135
  ds_write_b128 v10, v[208:211] offset:16384
  v_pk_mul_f32 v[136:137], v[136:137], v[188:189] op_sel:[0,1] op_sel_hi:[1,1]
  v_pk_mul_f32 v[138:139], v[138:139], v[188:189] op_sel:[0,1] op_sel_hi:[1,1]
  v_pk_mul_f32 v[140:141], v[140:141], v[188:189] op_sel:[0,1] op_sel_hi:[1,1]
  v_pk_mul_f32 v[142:143], v[142:143], v[188:189] op_sel:[0,1] op_sel_hi:[1,1]
  v_cvt_pk_bf16_f32 v212, v136, v137
  v_cvt_pk_bf16_f32 v213, v138, v139
  v_cvt_pk_bf16_f32 v214, v140, v141
  v_cvt_pk_bf16_f32 v215, v142, v143
  ds_write_b128 v11, v[212:215] offset:16384
  ds_read_b64_tr_b16 v[128:129], v26 offset:16384
  ds_read_b64_tr_b16 v[130:131], v27 offset:16384
  ds_read_b64_tr_b16 v[132:133], v26 offset:17408
  ds_read_b64_tr_b16 v[134:135], v27 offset:17408
  v_pk_mul_f32 v[80:81], v[80:81], v[188:189] op_sel_hi:[1,0]
  v_pk_mul_f32 v[82:83], v[82:83], v[188:189] op_sel_hi:[1,0]
  v_pk_mul_f32 v[84:85], v[84:85], v[188:189] op_sel_hi:[1,0]
  v_pk_mul_f32 v[86:87], v[86:87], v[188:189] op_sel_hi:[1,0]
  v_cvt_pk_bf16_f32 v208, v80, v81
  v_cvt_pk_bf16_f32 v209, v82, v83
  v_cvt_pk_bf16_f32 v210, v84, v85
  v_cvt_pk_bf16_f32 v211, v86, v87
  ds_write_b128 v10, v[208:211] offset:32768
  v_pk_mul_f32 v[88:89], v[88:89], v[188:189] op_sel:[0,1] op_sel_hi:[1,1]
  v_pk_mul_f32 v[90:91], v[90:91], v[188:189] op_sel:[0,1] op_sel_hi:[1,1]
  v_pk_mul_f32 v[92:93], v[92:93], v[188:189] op_sel:[0,1] op_sel_hi:[1,1]
  v_pk_mul_f32 v[94:95], v[94:95], v[188:189] op_sel:[0,1] op_sel_hi:[1,1]
  v_cvt_pk_bf16_f32 v212, v88, v89
  v_cvt_pk_bf16_f32 v213, v90, v91
  v_cvt_pk_bf16_f32 v214, v92, v93
  v_cvt_pk_bf16_f32 v215, v94, v95
  ds_write_b128 v11, v[212:215] offset:32768
  ds_read_b64_tr_b16 v[80:81], v26 offset:32768
  ds_read_b64_tr_b16 v[82:83], v27 offset:32768
  ds_read_b64_tr_b16 v[84:85], v26 offset:33792
  ds_read_b64_tr_b16 v[86:87], v27 offset:33792
  buffer_load_dwordx4 v[20:23], v24, s[16:19], s63 offen sc1
  s_waitcnt lgkmcnt(0)
  v_mfma_f32_16x16x32_bf16 v[228:231], v[64:67], v[204:207], 0
  v_mfma_f32_16x16x32_bf16 v[232:235], v[204:207], v[128:131], 0
  v_mfma_f32_16x16x32_bf16 v[224:227], v[80:83], v[204:207], 0
  v_mfma_f32_16x16x32_bf16 v[228:231], v[68:71], v[204:207], v[228:231]
  v_mfma_f32_16x16x32_bf16 v[232:235], v[204:207], v[132:135], v[232:235]
  v_mfma_f32_16x16x32_bf16 v[224:227], v[84:87], v[204:207], v[224:227]
  v_lshlrev_b32 v16, 4, v7
  v_add_u32 v16, 154880, v16
  v_lshlrev_b32 v17, 3, v8
  v_add_u32 v17, 154880, v17
  ds_write_b128 v30, v[216:219]
  s_nop 1
  v_mov_b32 v233, v220
  ds_write_b128 v30, v[228:231] offset:128
  ds_write_b64 v31, v[232:233] offset:192
  ds_write_b128 v30, v[224:227] offset:64
  s_waitcnt lgkmcnt(0)
  s_barrier
  ds_read_b64_tr_b16 v[236:237], v12 offset:0
  ds_read_b64_tr_b16 v[238:239], v13 offset:0
  ds_read_b64_tr_b16 v[240:241], v12 offset:16384
  ds_read_b64_tr_b16 v[242:243], v13 offset:16384
  ds_read_b64_tr_b16 v[244:245], v12 offset:1024
  ds_read_b64_tr_b16 v[246:247], v13 offset:1024
  ds_read_b64_tr_b16 v[248:249], v12 offset:17408
  ds_read_b64_tr_b16 v[250:251], v13 offset:17408
  s_lshr_b32 s20, s32, 2
  s_cmp_eq_u32 s20, 0
  s_cbranch_scc1 main_p1o
  s_setprio 1
main_p1o:
  ds_read_b64_tr_b16 v[176:177], v12 offset:2048
  ds_read_b64_tr_b16 v[178:179], v13 offset:2048
  ds_read_b64_tr_b16 v[180:181], v12 offset:18432
  ds_read_b64_tr_b16 v[182:183], v13 offset:18432
  s_waitcnt lgkmcnt(8)
  s_add_u32 s20, s28, s29
  s_add_u32 s21, s49, 8192
  s_mov_b32 m0, s21
  s_add_u32 s29, s29, 128
  buffer_load_dwordx4 v200, s[24:27], s20 offen offset:0 lds
  buffer_load_dwordx4 v201, s[24:27], s20 offen offset:1024 lds
  buffer_load_dwordx4 v202, s[24:27], s20 offen offset:2048 lds
  buffer_load_dwordx4 v203, s[24:27], s20 offen offset:3072 lds
  s_and_b32 s29, s29, 0x3ff
  v_mfma_f32_16x16x32_bf16 v[184:187], v[236:239], v[32:35], 0
  v_mfma_f32_16x16x32_bf16 v[192:195], v[32:35], v[240:243], 0
  v_mfma_f32_16x16x32_bf16 v[188:191], v[236:239], v[96:99], 0
  v_mfma_f32_16x16x32_bf16 v[196:199], v[96:99], v[240:243], 0
  s_cmp_lt_u32 s32, 6
  s_cbranch_scc1 Lrs_4
  v_lshlrev_b32 v18, 2, v0
  v_add_u32 v18, 153344, v18
  ds_read_b32 v208, v18 offset:0
  ds_read_b32 v209, v18 offset:320
  ds_read_b32 v210, v18 offset:640
  ds_read_b32 v211, v18 offset:960
  ds_read_b32 v212, v18 offset:1280
  ds_read_b32 v213, v18 offset:1600
  ds_read_b32 v214, v18 offset:1920
  ds_read_b32 v215, v18 offset:2240
  s_waitcnt lgkmcnt(0)
  v_add_f32 v208, v208, v209
  v_add_f32 v208, v208, v210
  v_add_f32 v208, v208, v211
  v_add_f32 v208, v208, v212
  v_add_f32 v208, v208, v213
  v_add_f32 v208, v208, v214
  v_add_f32 v208, v208, v215
  v_cmp_gt_u32 vcc, 464, v0
  s_nop 0
  s_and_saveexec_b64 s[20:21], vcc
  ds_write_b32 v18, v208
  s_mov_b64 exec, -1
Lrs_4:
  ds_read_b64_tr_b16 v[236:237], v12 offset:3072
  ds_read_b64_tr_b16 v[238:239], v13 offset:3072
  ds_read_b64_tr_b16 v[240:241], v12 offset:19456
  ds_read_b64_tr_b16 v[242:243], v13 offset:19456
  s_waitcnt lgkmcnt(4)
  s_add_u32 s20, s28, s29
  s_mov_b32 m0, s49
  s_add_u32 s29, s29, 128
  buffer_load_dwordx4 v200, s[24:27], s20 offen offset:0 lds
  buffer_load_dwordx4 v201, s[24:27], s20 offen offset:1024 lds
  buffer_load_dwordx4 v202, s[24:27], s20 offen offset:2048 lds
  buffer_load_dwordx4 v203, s[24:27], s20 offen offset:3072 lds
  s_and_b32 s29, s29, 0x3ff
  v_mfma_f32_16x16x32_bf16 v[184:187], v[244:247], v[36:39], v[184:187]
  v_mfma_f32_16x16x32_bf16 v[192:195], v[36:39], v[248:251], v[192:195]
  v_mfma_f32_16x16x32_bf16 v[188:191], v[244:247], v[100:103], v[188:191]
  v_mfma_f32_16x16x32_bf16 v[196:199], v[100:103], v[248:251], v[196:199]
  ds_read_b64_tr_b16 v[244:245], v12 offset:4096
  ds_read_b64_tr_b16 v[246:247], v13 offset:4096
  ds_read_b64_tr_b16 v[248:249], v12 offset:20480
  ds_read_b64_tr_b16 v[250:251], v13 offset:20480
  s_waitcnt lgkmcnt(4)
  v_mfma_f32_16x16x32_bf16 v[184:187], v[176:179], v[40:43], v[184:187]
  v_mfma_f32_16x16x32_bf16 v[192:195], v[40:43], v[180:183], v[192:195]
  v_mfma_f32_16x16x32_bf16 v[188:191], v[176:179], v[104:107], v[188:191]
  v_mfma_f32_16x16x32_bf16 v[196:199], v[104:107], v[180:183], v[196:199]
  s_waitcnt vmcnt(9)
  ds_read_b128 v[64:67], v254 offset:4096
  ds_read_b128 v[128:131], v254 offset:6144
  ds_read_b128 v[68:71], v255 offset:4096
  ds_read_b128 v[132:135], v255 offset:6144
  ds_read_b64_tr_b16 v[176:177], v12 offset:5120
  ds_read_b64_tr_b16 v[178:179], v13 offset:5120
  ds_read_b64_tr_b16 v[180:181], v12 offset:21504
  ds_read_b64_tr_b16 v[182:183], v13 offset:21504
  s_waitcnt lgkmcnt(4)
  s_add_u32 s20, s28, s29
  s_add_u32 s21, s49, 4096
  s_mov_b32 m0, s21
  s_add_u32 s29, s29, 128
  buffer_load_dwordx4 v200, s[24:27], s20 offen offset:0 lds
  buffer_load_dwordx4 v201, s[24:27], s20 offen offset:1024 lds
  buffer_load_dwordx4 v202, s[24:27], s20 offen offset:2048 lds
  buffer_load_dwordx4 v203, s[24:27], s20 offen offset:3072 lds
  s_and_b32 s29, s29, 0x3ff
  v_mfma_f32_16x16x32_bf16 v[184:187], v[236:239], v[44:47], v[184:187]
  v_mfma_f32_16x16x32_bf16 v[192:195], v[44:47], v[240:243], v[192:195]
  v_mfma_f32_16x16x32_bf16 v[188:191], v[236:239], v[108:111], v[188:191]
  v_mfma_f32_16x16x32_bf16 v[196:199], v[108:111], v[240:243], v[196:199]
  ds_read_b64_tr_b16 v[236:237], v12 offset:6144
  ds_read_b64_tr_b16 v[238:239], v13 offset:6144
  ds_read_b64_tr_b16 v[240:241], v12 offset:22528
  ds_read_b64_tr_b16 v[242:243], v13 offset:22528
  s_waitcnt lgkmcnt(4)
  v_mfma_f32_16x16x32_bf16 v[184:187], v[244:247], v[48:51], v[184:187]
  v_mfma_f32_16x16x32_bf16 v[192:195], v[48:51], v[248:251], v[192:195]
  v_mfma_f32_16x16x32_bf16 v[188:191], v[244:247], v[112:115], v[188:191]
  v_mfma_f32_16x16x32_bf16 v[196:199], v[112:115], v[248:251], v[196:199]
  ds_read_b64_tr_b16 v[244:245], v12 offset:7168
  ds_read_b64_tr_b16 v[246:247], v13 offset:7168
  ds_read_b64_tr_b16 v[248:249], v12 offset:23552
  ds_read_b64_tr_b16 v[250:251], v13 offset:23552
  s_waitcnt lgkmcnt(4)
  v_mfma_f32_16x16x32_bf16 v[184:187], v[176:179], v[52:55], v[184:187]
  v_mfma_f32_16x16x32_bf16 v[192:195], v[52:55], v[180:183], v[192:195]
  v_mfma_f32_16x16x32_bf16 v[188:191], v[176:179], v[116:119], v[188:191]
  v_mfma_f32_16x16x32_bf16 v[196:199], v[116:119], v[180:183], v[196:199]
  ds_read_b64_tr_b16 v[176:177], v12 offset:8192
  ds_read_b64_tr_b16 v[178:179], v13 offset:8192
  ds_read_b64_tr_b16 v[180:181], v12 offset:24576
  ds_read_b64_tr_b16 v[182:183], v13 offset:24576
  s_waitcnt lgkmcnt(4)
  v_mfma_f32_16x16x32_bf16 v[184:187], v[236:239], v[56:59], v[184:187]
  v_mfma_f32_16x16x32_bf16 v[192:195], v[56:59], v[240:243], v[192:195]
  v_mfma_f32_16x16x32_bf16 v[188:191], v[236:239], v[120:123], v[188:191]
  v_mfma_f32_16x16x32_bf16 v[196:199], v[120:123], v[240:243], v[196:199]
  ds_read_b64_tr_b16 v[236:237], v12 offset:9216
  ds_read_b64_tr_b16 v[238:239], v13 offset:9216
  ds_read_b64_tr_b16 v[240:241], v12 offset:25600
  ds_read_b64_tr_b16 v[242:243], v13 offset:25600
  s_waitcnt lgkmcnt(4)
  v_mfma_f32_16x16x32_bf16 v[184:187], v[244:247], v[60:63], v[184:187]
  v_mfma_f32_16x16x32_bf16 v[192:195], v[60:63], v[248:251], v[192:195]
  v_mfma_f32_16x16x32_bf16 v[188:191], v[244:247], v[124:127], v[188:191]
  v_mfma_f32_16x16x32_bf16 v[196:199], v[124:127], v[248:251], v[196:199]
  s_waitcnt vmcnt(8)
  ds_read_b128 v[72:75], v254 offset:8192
  ds_read_b128 v[136:139], v254 offset:10240
  ds_read_b128 v[76:79], v255 offset:8192
  ds_read_b128 v[140:143], v255 offset:10240
  ds_read_b64_tr_b16 v[244:245], v12 offset:10240
  ds_read_b64_tr_b16 v[246:247], v13 offset:10240
  ds_read_b64_tr_b16 v[248:249], v12 offset:26624
  ds_read_b64_tr_b16 v[250:251], v13 offset:26624
  s_waitcnt lgkmcnt(4)
  v_mfma_f32_16x16x32_bf16 v[184:187], v[176:179], v[64:67], v[184:187]
  v_mfma_f32_16x16x32_bf16 v[192:195], v[64:67], v[180:183], v[192:195]
  v_mfma_f32_16x16x32_bf16 v[188:191], v[176:179], v[128:131], v[188:191]
  v_mfma_f32_16x16x32_bf16 v[196:199], v[128:131], v[180:183], v[196:199]
  v_cmp_ne_u32 vcc, s48, v22
  s_cmp_eq_u64 vcc, 0
  s_cbranch_scc1 main_stok
  s_mov_b32 s60, 50000
Lst_5:
  buffer_load_dwordx4 v[20:23], v24, s[16:19], s63 offen sc1
  s_waitcnt vmcnt(0)
  v_cmp_ne_u32 vcc, s48, v22
  s_cmp_eq_u64 vcc, 0
  s_cbranch_scc1 Lstd_6
  s_sub_u32 s60, s60, 1
  s_sleep 4
  s_cmp_lg_u32 s60, 0
  s_cbranch_scc1 Lst_5
Lstd_6:
main_stok:
  s_lshl_b32 s21, s32, 8
  s_add_u32 s21, s21, 157440
  v_lshrrev_b32 v18, 1, v24
  v_add_u32 v18, s21, v18
  ds_write_b64 v18, v[20:21]
  v_lshl_add_u32 v18, v8, 3, s21
  v_lshl_add_u32 v19, v7, 5, s21
  ds_read_b64 v[204:205], v18 offset:0
  ds_read_b128 v[160:163], v19 offset:0
  ds_read_b128 v[164:167], v19 offset:16
  ds_read_b64 v[206:207], v18 offset:128
  ds_read_b128 v[168:171], v19 offset:128
  ds_read_b128 v[172:175], v19 offset:144
  ds_read_b64_tr_b16 v[176:177], v12 offset:11264
  ds_read_b64_tr_b16 v[178:179], v13 offset:11264
  ds_read_b64_tr_b16 v[180:181], v12 offset:27648
  ds_read_b64_tr_b16 v[182:183], v13 offset:27648
  s_waitcnt lgkmcnt(4)
  v_mfma_f32_16x16x32_bf16 v[184:187], v[236:239], v[68:71], v[184:187]
  v_mfma_f32_16x16x32_bf16 v[192:195], v[68:71], v[240:243], v[192:195]
  v_mfma_f32_16x16x32_bf16 v[188:191], v[236:239], v[132:135], v[188:191]
  v_mfma_f32_16x16x32_bf16 v[196:199], v[132:135], v[240:243], v[196:199]
  s_waitcnt vmcnt(4)
  ds_read_b128 v[80:83], v254 offset:0
  ds_read_b128 v[144:147], v254 offset:2048
  ds_read_b128 v[84:87], v255 offset:0
  ds_read_b128 v[148:151], v255 offset:2048
  ds_read_b64_tr_b16 v[236:237], v12 offset:12288
  ds_read_b64_tr_b16 v[238:239], v13 offset:12288
  ds_read_b64_tr_b16 v[240:241], v12 offset:28672
  ds_read_b64_tr_b16 v[242:243], v13 offset:28672
  s_waitcnt lgkmcnt(4)
  v_mfma_f32_16x16x32_bf16 v[184:187], v[244:247], v[72:75], v[184:187]
  v_mfma_f32_16x16x32_bf16 v[192:195], v[72:75], v[248:251], v[192:195]
  v_mfma_f32_16x16x32_bf16 v[188:191], v[244:247], v[136:139], v[188:191]
  v_mfma_f32_16x16x32_bf16 v[196:199], v[136:139], v[248:251], v[196:199]
  ds_read_b64_tr_b16 v[244:245], v12 offset:13312
  ds_read_b64_tr_b16 v[246:247], v13 offset:13312
  ds_read_b64_tr_b16 v[248:249], v12 offset:29696
  ds_read_b64_tr_b16 v[250:251], v13 offset:29696
  s_waitcnt lgkmcnt(4)
  v_mfma_f32_16x16x32_bf16 v[184:187], v[176:179], v[76:79], v[184:187]
  v_mfma_f32_16x16x32_bf16 v[192:195], v[76:79], v[180:183], v[192:195]
  v_mfma_f32_16x16x32_bf16 v[188:191], v[176:179], v[140:143], v[188:191]
  v_mfma_f32_16x16x32_bf16 v[196:199], v[140:143], v[180:183], v[196:199]
  s_setprio 0
  s_waitcnt vmcnt(0)
  ds_read_b128 v[88:91], v254 offset:4096
  ds_read_b128 v[152:155], v254 offset:6144
  ds_read_b128 v[92:95], v255 offset:4096
  ds_read_b128 v[156:159], v255 offset:6144
  ds_read_b64_tr_b16 v[176:177], v12 offset:14336
  ds_read_b64_tr_b16 v[178:179], v13 offset:14336
  ds_read_b64_tr_b16 v[180:181], v12 offset:30720
  ds_read_b64_tr_b16 v[182:183], v13 offset:30720
  s_waitcnt lgkmcnt(4)
  v_mfma_f32_16x16x32_bf16 v[184:187], v[236:239], v[80:83], v[184:187]
  v_mfma_f32_16x16x32_bf16 v[192:195], v[80:83], v[240:243], v[192:195]
  v_mfma_f32_16x16x32_bf16 v[188:191], v[236:239], v[144:147], v[188:191]
  v_mfma_f32_16x16x32_bf16 v[196:199], v[144:147], v[240:243], v[196:199]
  ds_read_b64_tr_b16 v[236:237], v12 offset:15360
  ds_read_b64_tr_b16 v[238:239], v13 offset:15360
  ds_read_b64_tr_b16 v[240:241], v12 offset:31744
  ds_read_b64_tr_b16 v[242:243], v13 offset:31744
  s_waitcnt lgkmcnt(4)
  v_mfma_f32_16x16x32_bf16 v[184:187], v[244:247], v[84:87], v[184:187]
  v_mfma_f32_16x16x32_bf16 v[192:195], v[84:87], v[248:251], v[192:195]
  v_mfma_f32_16x16x32_bf16 v[188:191], v[244:247], v[148:151], v[188:191]
  v_mfma_f32_16x16x32_bf16 v[196:199], v[148:151], v[248:251], v[196:199]
  s_lshl_b32 s34, s31, 3
  s_add_u32 s34, s34, s32
  s_lshl_b32 s22, s30, 17
  s_add_u32 s35, s22, 5242880
  s_lshl_b32 s23, s34, 11
  s_add_u32 s22, s35, s23
  v_and_b32 v18, 1, v7
  v_lshlrev_b32 v18, 9, v18
  v_lshrrev_b32 v19, 1, v7
  v_lshl_add_u32 v18, v19, 8, v18
  v_lshl_add_u32 v18, v8, 4, v18
  s_lshl_b32 s23, s32, 11
  v_add_u32 v19, s23, v9
  v_add_u32 v20, s23, v18
  s_waitcnt lgkmcnt(4)
  v_mfma_f32_16x16x32_bf16 v[184:187], v[176:179], v[88:91], v[184:187]
  v_mfma_f32_16x16x32_bf16 v[192:195], v[88:91], v[180:183], v[192:195]
  v_mfma_f32_16x16x32_bf16 v[188:191], v[176:179], v[152:155], v[188:191]
  v_mfma_f32_16x16x32_bf16 v[196:199], v[152:155], v[180:183], v[196:199]
  s_waitcnt lgkmcnt(0)
  v_mfma_f32_16x16x32_bf16 v[184:187], v[236:239], v[92:95], v[184:187]
  v_mfma_f32_16x16x32_bf16 v[192:195], v[92:95], v[240:243], v[192:195]
  v_mfma_f32_16x16x32_bf16 v[188:191], v[236:239], v[156:159], v[188:191]
  v_mfma_f32_16x16x32_bf16 v[196:199], v[156:159], v[240:243], v[196:199]
  ds_read_b64_tr_b16 v[236:237], v12 offset:32768
  ds_read_b64_tr_b16 v[238:239], v13 offset:32768
  ds_read_b64_tr_b16 v[240:241], v12 offset:33792
  ds_read_b64_tr_b16 v[242:243], v13 offset:33792
  s_barrier
  ds_read_b128 v[208:211], v16 offset:0
  ds_read_b128 v[212:215], v16 offset:64
  ds_read_b128 v[220:223], v16 offset:128
  ds_read_b64 v[224:225], v17 offset:192
  s_waitcnt lgkmcnt(0)
  v_fma_f32 v184, -v204, v220, v184
  v_mul_f32 v184, v184, v205
  v_fma_f32 v185, -v204, v221, v185
  v_mul_f32 v185, v185, v205
  v_fma_f32 v186, -v204, v222, v186
  v_mul_f32 v186, v186, v205
  v_fma_f32 v187, -v204, v223, v187
  v_mul_f32 v187, v187, v205
  v_cvt_pk_bf16_f32 v228, v184, v185
  v_cvt_pk_bf16_f32 v229, v186, v187
  v_fma_f32 v188, -v206, v220, v188
  v_mul_f32 v188, v188, v207
  v_fma_f32 v189, -v206, v221, v189
  v_mul_f32 v189, v189, v207
  v_fma_f32 v190, -v206, v222, v190
  v_mul_f32 v190, v190, v207
  v_fma_f32 v191, -v206, v223, v191
  v_mul_f32 v191, v191, v207
  v_cvt_pk_bf16_f32 v230, v188, v189
  v_cvt_pk_bf16_f32 v231, v190, v191
  v_fma_f32 v192, -v160, v224, v192
  v_fma_f32 v192, v192, v161, v225
  v_fma_f32 v193, -v162, v224, v193
  v_fma_f32 v193, v193, v163, v225
  v_fma_f32 v194, -v164, v224, v194
  v_fma_f32 v194, v194, v165, v225
  v_fma_f32 v195, -v166, v224, v195
  v_fma_f32 v195, v195, v167, v225
  v_permlane16_swap_b32 v228, v230
  v_permlane16_swap_b32 v229, v231
  buffer_store_dwordx4 v[228:231], v9, s[16:19], s22 offen sc1
  v_cvt_pk_bf16_f32 v232, v192, v193
  v_cvt_pk_bf16_f32 v233, v194, v195
  v_fma_f32 v196, -v168, v224, v196
  v_fma_f32 v196, v196, v169, v225
  v_fma_f32 v197, -v170, v224, v197
  v_fma_f32 v197, v197, v171, v225
  v_fma_f32 v198, -v172, v224, v198
  v_fma_f32 v198, v198, v173, v225
  v_fma_f32 v199, -v174, v224, v199
  v_fma_f32 v199, v199, v175, v225
  v_cvt_pk_bf16_f32 v234, v196, v197
  v_cvt_pk_bf16_f32 v235, v198, v199
  ds_write_b128 v19, v[228:231]
  s_nop 0
  v_permlane16_swap_b32 v232, v234
  v_permlane16_swap_b32 v233, v235
  buffer_store_dwordx4 v[232:235], v18, s[16:19], s22 offen offset:1024 sc1
  ds_write_b128 v20, v[232:235] offset:1024
  s_sub_u32 s20, s32, 1
  s_cmp_gt_u32 s20, 1
  s_cbranch_scc1 Lrz_8
  v_mov_b32 v216, -1
  v_mov_b32 v217, -1
  v_mov_b32 v218, -1
  v_mov_b32 v219, -1
  s_lshl_b32 s22, s2, 10
  s_add_u32 s22, s22, 524288
  s_lshl_b32 s23, s2, 6
  s_add_u32 s23, s23, 409600
  s_cmp_eq_u32 s32, 1
  s_cselect_b32 s22, s22, s23
  s_cselect_b32 s20, -1, 15
  s_cselect_b32 s21, -1, 0
  s_mov_b64 exec, s[20:21]
  buffer_store_dwordx4 v[216:219], v9, s[16:19], s22 offen sc1
  s_mov_b64 exec, -1
Lrz_8:
  ds_read_b64_tr_b16 v[244:245], v12 offset:34816
  ds_read_b64_tr_b16 v[246:247], v13 offset:34816
  ds_read_b64_tr_b16 v[248:249], v12 offset:35840
  ds_read_b64_tr_b16 v[250:251], v13 offset:35840
  s_waitcnt lgkmcnt(6)
  v_mfma_f32_16x16x32_bf16 v[176:179], v[236:239], v[32:35], 0
  v_mfma_f32_16x16x32_bf16 v[180:183], v[236:239], v[96:99], 0
  ds_read_b64_tr_b16 v[236:237], v12 offset:36864
  ds_read_b64_tr_b16 v[238:239], v13 offset:36864
  s_waitcnt lgkmcnt(6)
  v_mfma_f32_16x16x32_bf16 v[176:179], v[240:243], v[36:39], v[176:179]
  v_mfma_f32_16x16x32_bf16 v[180:183], v[240:243], v[100:103], v[180:183]
  ds_read_b64_tr_b16 v[240:241], v12 offset:37888
  ds_read_b64_tr_b16 v[242:243], v13 offset:37888
  s_waitcnt lgkmcnt(6)
  v_mfma_f32_16x16x32_bf16 v[176:179], v[244:247], v[40:43], v[176:179]
  v_mfma_f32_16x16x32_bf16 v[180:183], v[244:247], v[104:107], v[180:183]
  ds_read_b64_tr_b16 v[244:245], v12 offset:38912
  ds_read_b64_tr_b16 v[246:247], v13 offset:38912
  s_waitcnt lgkmcnt(6)
  v_mfma_f32_16x16x32_bf16 v[176:179], v[248:251], v[44:47], v[176:179]
  v_mfma_f32_16x16x32_bf16 v[180:183], v[248:251], v[108:111], v[180:183]
  ds_read_b64_tr_b16 v[248:249], v12 offset:39936
  ds_read_b64_tr_b16 v[250:251], v13 offset:39936
  s_waitcnt lgkmcnt(6)
  v_mfma_f32_16x16x32_bf16 v[176:179], v[236:239], v[48:51], v[176:179]
  v_and_b32 v25, 31, v2
  v_cmp_eq_u32 vcc, 16, v25
  v_mov_b32 v25, 0x3f803f80
  v_mfma_f32_16x16x32_bf16 v[180:183], v[236:239], v[112:115], v[180:183]
  s_lshl_b32 s36, s32, 12
  s_add_u32 s36, s36, 131072
  ds_read_b64_tr_b16 v[236:237], v12 offset:40960
  ds_read_b64_tr_b16 v[238:239], v13 offset:40960
  s_waitcnt lgkmcnt(6)
  v_mfma_f32_16x16x32_bf16 v[176:179], v[240:243], v[52:55], v[176:179]
  v_cndmask_b32 v25, 0, v25, vcc
  v_mov_b32 v110, v5
  v_mov_b32 v111, v4
  v_mfma_f32_16x16x32_bf16 v[180:183], v[240:243], v[116:119], v[180:183]
  v_mov_b32 v10, v29
  v_mov_b32 v11, v28
  ds_read_b64_tr_b16 v[240:241], v12 offset:41984
  ds_read_b64_tr_b16 v[242:243], v13 offset:41984
  s_waitcnt lgkmcnt(6)
  v_mfma_f32_16x16x32_bf16 v[176:179], v[244:247], v[56:59], v[176:179]
  v_mov_b32 v3, v9
  v_lshrrev_b32 v4, 5, v2
  v_lshlrev_b32 v4, 8, v4
  v_mfma_f32_16x16x32_bf16 v[180:183], v[244:247], v[120:123], v[180:183]
  v_lshl_add_u32 v4, v8, 4, v4
  v_add_u32 v4, 1024, v4
  ds_read_b64_tr_b16 v[244:245], v12 offset:43008
  ds_read_b64_tr_b16 v[246:247], v13 offset:43008
  s_waitcnt lgkmcnt(6)
  v_mfma_f32_16x16x32_bf16 v[176:179], v[248:251], v[60:63], v[176:179]
  s_mov_b32 s38, 0x0000ffff
  s_mov_b32 s39, 0x0000ffff
  s_mov_b32 s37, 0
  v_mfma_f32_16x16x32_bf16 v[180:183], v[248:251], v[124:127], v[180:183]
  v_mov_b32 v96, v25
  v_mov_b32 v97, v25
  ds_read_b64_tr_b16 v[248:249], v12 offset:44032
  ds_read_b64_tr_b16 v[250:251], v13 offset:44032
  s_waitcnt lgkmcnt(6)
  v_mfma_f32_16x16x32_bf16 v[176:179], v[236:239], v[64:67], v[176:179]
  v_mov_b32 v98, v25
  v_mov_b32 v99, v25
  v_mov_b32 v100, v25
  v_mfma_f32_16x16x32_bf16 v[180:183], v[236:239], v[128:131], v[180:183]
  v_mov_b32 v101, v25
  v_mov_b32 v102, v25
  ds_read_b64_tr_b16 v[236:237], v12 offset:45056
  ds_read_b64_tr_b16 v[238:239], v13 offset:45056
  s_waitcnt lgkmcnt(6)
  v_mfma_f32_16x16x32_bf16 v[176:179], v[240:243], v[68:71], v[176:179]
  v_mov_b32 v103, v25
  v_mov_b32 v104, v25
  v_mov_b32 v105, v25
  v_mfma_f32_16x16x32_bf16 v[180:183], v[240:243], v[132:135], v[180:183]
  v_mov_b32 v106, v25
  v_mov_b32 v107, v25
  ds_read_b64_tr_b16 v[240:241], v12 offset:46080
  ds_read_b64_tr_b16 v[242:243], v13 offset:46080
  s_waitcnt lgkmcnt(6)
  v_mfma_f32_16x16x32_bf16 v[176:179], v[244:247], v[72:75], v[176:179]
  v_mov_b32 v108, 0xdddddddd
  s_mov_b32 s24, 0x3eb8aa3b
  v_mul_f32 v208, s24, v208
  v_mfma_f32_16x16x32_bf16 v[180:183], v[244:247], v[136:139], v[180:183]
  v_mul_f32 v209, s24, v209
  v_mul_f32 v210, s24, v210
  s_lshl_b32 s20, s31, 7
  s_add_u32 s20, s20, s40
  v_mov_b32 v6, 0
  v_mov_b32 v7, s48
  s_waitcnt vmcnt(0)
  s_mov_b64 exec, 1
  buffer_store_dword v7, v6, s[16:19], s20 offen sc1
  s_mov_b64 exec, -1
  ds_read_b64_tr_b16 v[244:245], v12 offset:47104
  ds_read_b64_tr_b16 v[246:247], v13 offset:47104
  s_waitcnt lgkmcnt(6)
  v_mfma_f32_16x16x32_bf16 v[176:179], v[248:251], v[76:79], v[176:179]
  v_mul_f32 v211, s24, v211
  v_mul_f32 v205, s24, v205
  v_mfma_f32_16x16x32_bf16 v[180:183], v[248:251], v[140:143], v[180:183]
  v_mul_f32 v207, s24, v207
  ds_read_b64_tr_b16 v[248:249], v12 offset:48128
  ds_read_b64_tr_b16 v[250:251], v13 offset:48128
  s_waitcnt lgkmcnt(6)
  v_mfma_f32_16x16x32_bf16 v[176:179], v[236:239], v[80:83], v[176:179]
  v_mov_b32 v68, 0
  v_mov_b32 v69, 0
  v_mfma_f32_16x16x32_bf16 v[180:183], v[236:239], v[144:147], v[180:183]
  v_mov_b32 v70, 0
  v_mov_b32 v71, 0
  s_waitcnt lgkmcnt(4)
  v_mfma_f32_16x16x32_bf16 v[176:179], v[240:243], v[84:87], v[176:179]
  v_mov_b32 v72, 0
  v_mov_b32 v73, 0
  v_mfma_f32_16x16x32_bf16 v[180:183], v[240:243], v[148:151], v[180:183]
  v_mov_b32 v74, 0
  v_mov_b32 v75, 0
  s_waitcnt lgkmcnt(2)
  v_mfma_f32_16x16x32_bf16 v[176:179], v[244:247], v[88:91], v[176:179]
  v_mov_b32 v76, 0
  v_mov_b32 v77, 0
  v_mfma_f32_16x16x32_bf16 v[180:183], v[244:247], v[152:155], v[180:183]
  v_mov_b32 v78, 0
  v_mov_b32 v79, 0
  s_waitcnt lgkmcnt(0)
  v_mfma_f32_16x16x32_bf16 v[176:179], v[248:251], v[92:95], v[176:179]
  v_mov_b32 v80, 0
  v_mov_b32 v81, 0
  v_mfma_f32_16x16x32_bf16 v[180:183], v[248:251], v[156:159], v[180:183]
  v_mov_b32 v82, 0
  v_mov_b32 v83, 0
  v_mov_b32 v92, v25
  v_mov_b32 v93, v25
  v_mov_b32 v94, v25
  v_mov_b32 v95, v25
  v_fma_f32 v176, -v204, v212, v176
  v_fma_f32 v176, v176, v205, v208
  v_fma_f32 v177, -v204, v213, v177
  v_fma_f32 v177, v177, v205, v209
  v_fma_f32 v178, -v204, v214, v178
  v_fma_f32 v178, v178, v205, v210
  v_fma_f32 v179, -v204, v215, v179
  v_fma_f32 v179, v179, v205, v211
  v_cvt_pk_bf16_f32 v16, v176, v177
  v_cvt_pk_bf16_f32 v17, v178, v179
  v_fma_f32 v180, -v206, v212, v180
  v_fma_f32 v180, v180, v207, v208
  v_fma_f32 v181, -v206, v213, v181
  v_fma_f32 v181, v181, v207, v209
  v_fma_f32 v182, -v206, v214, v182
  v_fma_f32 v182, v182, v207, v210
  v_fma_f32 v183, -v206, v215, v183
  v_fma_f32 v183, v183, v207, v211
  v_cvt_pk_bf16_f32 v18, v180, v181
  v_cvt_pk_bf16_f32 v19, v182, v183
  s_nop 1
  v_permlane16_swap_b32 v16, v18
  v_permlane16_swap_b32 v17, v19
  s_barrier
  ds_read_b128 v[84:87], v3
  ds_read_b128 v[88:91], v3 offset:2048
  s_and_b32 s28, s32, 3
  s_lshl_b32 s20, s30, 13
  s_lshl_b32 s21, s28, 11
  s_add_u32 s40, s20, s21
  s_add_u32 s40, s40, 1048576
  v_lshlrev_b32 v12, 7, v8
  buffer_load_dword v13, v12, s[16:19], s40 offen sc1
  s_lshl_b32 s28, s28, 12
  s_lshl_b32 s20, 14, s31
  s_lshr_b32 s21, s20, 8
  s_or_b32 s20, s20, s21
  s_and_b32 s20, s20, 0xff
  s_lshl_b32 s21, 1, s31
  s_or_b32 s21, s21, s20
  s_xor_b32 s20, s20, 0xff
  s_add_u32 s22, s28, 49152
  s_cmp_gt_u32 s32, 3
  s_cselect_b32 s43, s21, s20
  s_cselect_b32 s61, s22, s28
  s_waitcnt lgkmcnt(1)
  v_mfma_f32_32x32x16_bf16 v[36:51], v[84:87], v[16:19], 0
  s_nop 11
  v_max3_f32 v6, v36, v37, v38
  v_max3_f32 v6, v6, v39, v40
  v_max3_f32 v6, v6, v41, v42
  v_max3_f32 v6, v6, v43, v44
  v_max3_f32 v6, v6, v45, v46
  v_max3_f32 v6, v6, v47, v48
  v_max3_f32 v6, v6, v49, v50
  v_max_f32 v6, v6, v51
  v_mov_b32 v7, v6
  s_nop 1
  v_permlane32_swap_b32 v7, v6
  s_nop 1
  v_max_f32 v6, v6, v7
  v_sub_f32 v20, 0, v6
  v_sub_f32 v21, 0, v6
  v_sub_f32 v22, 0, v6
  v_sub_f32 v23, 0, v6
  v_sub_f32 v24, 0, v6
  v_sub_f32 v25, 0, v6
  v_sub_f32 v26, 0, v6
  v_sub_f32 v27, 0, v6
  v_sub_f32 v28, 0, v6
  v_sub_f32 v29, 0, v6
  v_sub_f32 v30, 0, v6
  v_sub_f32 v31, 0, v6
  v_sub_f32 v32, 0, v6
  v_sub_f32 v33, 0, v6
  v_sub_f32 v34, 0, v6
  v_sub_f32 v35, 0, v6
  s_mov_b64 exec, s[38:39]
  ds_read_b128 v[92:95], v4
  ds_read_b128 v[96:99], v4 offset:512
  s_mov_b64 exec, -1
  v_mfma_f32_32x32x16_bf16 v[36:51], v[84:87], v[16:19], v[20:35]
  v_mov_b32 v60, 0
  v_mov_b32 v61, 0
  v_mov_b32 v62, 0
  v_mov_b32 v63, 0
  v_mov_b32 v64, 0
  v_mov_b32 v65, 0
  v_mov_b32 v66, 0
  v_mov_b32 v67, 0
  s_nop 3
  s_waitcnt lgkmcnt(0)
  v_exp_f32 v36, v36
  v_exp_f32 v37, v37
  v_exp_f32 v38, v38
  v_smfmac_f32_32x32x32_bf16 v[68:83], v[104:107], v[60:67], v108
  v_exp_f32 v39, v39
  v_exp_f32 v40, v40
  v_exp_f32 v41, v41
  v_exp_f32 v42, v42
  v_mfma_f32_32x32x16_bf16 v[52:67], v[88:91], v[16:19], v[20:35]
  ds_read_b128 v[84:87], v3 offset:4096
  s_mov_b64 exec, s[38:39]
  ds_read_b128 v[100:103], v4 offset:2048
  ds_read_b128 v[104:107], v4 offset:2560
  s_mov_b64 exec, -1
  v_exp_f32 v43, v43
  v_exp_f32 v44, v44
  v_exp_f32 v45, v45
  v_exp_f32 v46, v46
  v_exp_f32 v47, v47
  v_smfmac_f32_32x32x32_bf16 v[68:83], v[92:95], v[36:43], v108
  v_exp_f32 v48, v48
  v_exp_f32 v49, v49
  v_exp_f32 v50, v50
  v_exp_f32 v51, v51
  s_waitcnt lgkmcnt(0)
  v_exp_f32 v52, v52
  v_exp_f32 v53, v53
  v_exp_f32 v54, v54
  v_smfmac_f32_32x32x32_bf16 v[68:83], v[96:99], v[44:51], v108
  v_exp_f32 v55, v55
  v_exp_f32 v56, v56
  v_exp_f32 v57, v57
  v_exp_f32 v58, v58
  v_mfma_f32_32x32x16_bf16 v[36:51], v[84:87], v[16:19], v[20:35]
  ds_read_b128 v[88:91], v3 offset:6144
  s_mov_b64 exec, s[38:39]
  ds_read_b128 v[92:95], v4 offset:4096
  ds_read_b128 v[96:99], v4 offset:4608
  s_mov_b64 exec, -1
  v_exp_f32 v59, v59
  v_exp_f32 v60, v60
  v_exp_f32 v61, v61
  v_exp_f32 v62, v62
  v_exp_f32 v63, v63
  v_smfmac_f32_32x32x32_bf16 v[68:83], v[100:103], v[52:59], v108
  v_exp_f32 v64, v64
  v_exp_f32 v65, v65
  v_exp_f32 v66, v66
  v_exp_f32 v67, v67
  s_waitcnt lgkmcnt(0)
  s_cmp_gt_u32 s32, 3
  s_cbranch_scc1 Lold_9
  s_mov_b32 s60, 50000
Lkv_10:
  s_waitcnt vmcnt(0)
  v_cmp_eq_u32 vcc, s48, v13
  s_lshr_b32 s21, vcc_lo, 8
  s_and_b32 s29, vcc_lo, s21
  s_and_b32 s29, s29, 0xff
Lkp_11:
  s_cmp_ge_u32 s61, 49152
  s_cbranch_scc1 Lkd_13
  s_andn2_b32 s20, s29, s43
  s_cbranch_scc0 Lkm_12
  s_ff1_i32_b32 s21, s20
  s_bitset1_b32 s43, s21
  s_add_u32 s61, s61, 16384
  s_mov_b32 m0, s61
  s_lshl_b32 s21, s21, 14
  s_add_u32 s21, s21, s28
  s_add_u32 s21, s21, s35
  buffer_load_dwordx4 v9, s[16:19], s21 offen offset:0 sc1 lds
  buffer_load_dwordx4 v9, s[16:19], s21 offen offset:1024 sc1 lds
  buffer_load_dwordx4 v9, s[16:19], s21 offen offset:2048 sc1 lds
  buffer_load_dwordx4 v9, s[16:19], s21 offen offset:3072 sc1 lds
  s_branch Lkp_11
Lkm_12:
  s_cmp_ge_u32 s61, 16384
  s_cbranch_scc1 Lkd_13
  buffer_load_dword v13, v12, s[16:19], s40 offen sc1
  s_sub_u32 s60, s60, 1
  s_cmp_lg_u32 s60, 0
  s_cbranch_scc1 Lkv_10
Lkd_13:
Lold_9:
  v_exp_f32 v36, v36
  v_exp_f32 v37, v37
  v_exp_f32 v38, v38
  v_smfmac_f32_32x32x32_bf16 v[68:83], v[104:107], v[60:67], v108
  v_exp_f32 v39, v39
  v_exp_f32 v40, v40
  v_exp_f32 v41, v41
  v_exp_f32 v42, v42
  v_mfma_f32_32x32x16_bf16 v[52:67], v[88:91], v[16:19], v[20:35]
  ds_read_b128 v[84:87], v3 offset:8192
  s_mov_b64 exec, s[38:39]
  ds_read_b128 v[100:103], v4 offset:6144
  ds_read_b128 v[104:107], v4 offset:6656
  s_mov_b64 exec, -1
  v_exp_f32 v43, v43
  v_exp_f32 v44, v44
  v_exp_f32 v45, v45
  v_exp_f32 v46, v46
  v_exp_f32 v47, v47
  v_smfmac_f32_32x32x32_bf16 v[68:83], v[92:95], v[36:43], v108
  v_exp_f32 v48, v48
  v_exp_f32 v49, v49
  v_exp_f32 v50, v50
  v_exp_f32 v51, v51
  s_waitcnt lgkmcnt(0)
  v_exp_f32 v52, v52
  v_exp_f32 v53, v53
  v_exp_f32 v54, v54
  v_smfmac_f32_32x32x32_bf16 v[68:83], v[96:99], v[44:51], v108
  v_exp_f32 v55, v55
  v_exp_f32 v56, v56
  v_exp_f32 v57, v57
  v_exp_f32 v58, v58
  v_mfma_f32_32x32x16_bf16 v[36:51], v[84:87], v[16:19], v[20:35]
  ds_read_b128 v[88:91], v3 offset:10240
  s_mov_b64 exec, s[38:39]
  ds_read_b128 v[92:95], v4 offset:8192
  ds_read_b128 v[96:99], v4 offset:8704
  s_mov_b64 exec, -1
  v_exp_f32 v59, v59
  v_exp_f32 v60, v60
  v_exp_f32 v61, v61
  v_exp_f32 v62, v62
  v_exp_f32 v63, v63
  v_smfmac_f32_32x32x32_bf16 v[68:83], v[100:103], v[52:59], v108
  v_exp_f32 v64, v64
  v_exp_f32 v65, v65
  v_exp_f32 v66, v66
  v_exp_f32 v67, v67
  s_waitcnt lgkmcnt(0)
  s_cmp_lt_u32 s32, 4
  s_cbranch_scc1 Lyg_14
  s_mov_b32 s60, 50000
Lkv_15:
  s_waitcnt vmcnt(0)
  v_cmp_eq_u32 vcc, s48, v13
  s_lshr_b32 s21, vcc_lo, 8
  s_and_b32 s29, vcc_lo, s21
  s_and_b32 s29, s29, 0xff
Lkp_16:
  s_cmp_ge_u32 s61, 114688
  s_cbranch_scc1 Lkd_18
  s_andn2_b32 s20, s29, s43
  s_cbranch_scc0 Lkm_17
  s_ff1_i32_b32 s21, s20
  s_bitset1_b32 s43, s21
  s_add_u32 s61, s61, 16384
  s_mov_b32 m0, s61
  s_lshl_b32 s21, s21, 14
  s_add_u32 s21, s21, s28
  s_add_u32 s21, s21, s35
  buffer_load_dwordx4 v9, s[16:19], s21 offen offset:0 sc1 lds
  buffer_load_dwordx4 v9, s[16:19], s21 offen offset:1024 sc1 lds
  buffer_load_dwordx4 v9, s[16:19], s21 offen offset:2048 sc1 lds
  buffer_load_dwordx4 v9, s[16:19], s21 offen offset:3072 sc1 lds
  s_branch Lkp_16
Lkm_17:
  s_cmp_ge_u32 s61, 0
  s_cbranch_scc1 Lkd_18
  buffer_load_dword v13, v12, s[16:19], s40 offen sc1
  s_sub_u32 s60, s60, 1
  s_cmp_lg_u32 s60, 0
  s_cbranch_scc1 Lkv_15
Lkd_18:
Lyg_14:
  v_exp_f32 v36, v36
  v_exp_f32 v37, v37
  v_exp_f32 v38, v38
  v_smfmac_f32_32x32x32_bf16 v[68:83], v[104:107], v[60:67], v108
  v_exp_f32 v39, v39
  v_exp_f32 v40, v40
  v_exp_f32 v41, v41
  v_exp_f32 v42, v42
  v_mfma_f32_32x32x16_bf16 v[52:67], v[88:91], v[16:19], v[20:35]
  ds_read_b128 v[84:87], v3 offset:12288
  s_mov_b64 exec, s[38:39]
  ds_read_b128 v[100:103], v4 offset:10240
  ds_read_b128 v[104:107], v4 offset:10752
  s_mov_b64 exec, -1
  v_exp_f32 v43, v43
  v_exp_f32 v44, v44
  v_exp_f32 v45, v45
  v_exp_f32 v46, v46
  v_exp_f32 v47, v47
  v_smfmac_f32_32x32x32_bf16 v[68:83], v[92:95], v[36:43], v108
  v_exp_f32 v48, v48
  v_exp_f32 v49, v49
  v_exp_f32 v50, v50
  v_exp_f32 v51, v51
  s_waitcnt lgkmcnt(0)
  s_cmp_gt_u32 s32, 3
  s_cbranch_scc1 Lold_19
  s_mov_b32 s60, 50000
  s_branch Lkp_21
Lkv_20:
  s_waitcnt vmcnt(0)
  v_cmp_eq_u32 vcc, s48, v13
  s_lshr_b32 s21, vcc_lo, 8
  s_and_b32 s29, vcc_lo, s21
  s_and_b32 s29, s29, 0xff
Lkp_21:
  s_cmp_ge_u32 s61, 49152
  s_cbranch_scc1 Lkd_23
  s_andn2_b32 s20, s29, s43
  s_cbranch_scc0 Lkm_22
  s_ff1_i32_b32 s21, s20
  s_bitset1_b32 s43, s21
  s_add_u32 s61, s61, 16384
  s_mov_b32 m0, s61
  s_lshl_b32 s21, s21, 14
  s_add_u32 s21, s21, s28
  s_add_u32 s21, s21, s35
  buffer_load_dwordx4 v9, s[16:19], s21 offen offset:0 sc1 lds
  buffer_load_dwordx4 v9, s[16:19], s21 offen offset:1024 sc1 lds
  buffer_load_dwordx4 v9, s[16:19], s21 offen offset:2048 sc1 lds
  buffer_load_dwordx4 v9, s[16:19], s21 offen offset:3072 sc1 lds
  s_branch Lkp_21
Lkm_22:
  s_cmp_ge_u32 s61, 49152
  s_cbranch_scc1 Lkd_23
  buffer_load_dword v13, v12, s[16:19], s40 offen sc1
  s_sub_u32 s60, s60, 1
  s_cmp_lg_u32 s60, 0
  s_cbranch_scc1 Lkv_20
Lkd_23:
Lold_19:
  v_exp_f32 v52, v52
  v_exp_f32 v53, v53
  v_exp_f32 v54, v54
  v_smfmac_f32_32x32x32_bf16 v[68:83], v[96:99], v[44:51], v108
  v_exp_f32 v55, v55
  v_exp_f32 v56, v56
  v_exp_f32 v57, v57
  v_exp_f32 v58, v58
  v_mfma_f32_32x32x16_bf16 v[36:51], v[84:87], v[16:19], v[20:35]
  ds_read_b128 v[88:91], v3 offset:14336
  s_mov_b64 exec, s[38:39]
  ds_read_b128 v[92:95], v4 offset:12288
  ds_read_b128 v[96:99], v4 offset:12800
  s_mov_b64 exec, -1
  v_exp_f32 v59, v59
  v_exp_f32 v60, v60
  v_exp_f32 v61, v61
  v_exp_f32 v62, v62
  v_exp_f32 v63, v63
  v_smfmac_f32_32x32x32_bf16 v[68:83], v[100:103], v[52:59], v108
  v_exp_f32 v64, v64
  v_exp_f32 v65, v65
  v_exp_f32 v66, v66
  v_exp_f32 v67, v67
  s_waitcnt lgkmcnt(0)
  v_exp_f32 v36, v36
  v_exp_f32 v37, v37
  v_exp_f32 v38, v38
  v_smfmac_f32_32x32x32_bf16 v[68:83], v[104:107], v[60:67], v108
  v_exp_f32 v39, v39
  v_exp_f32 v40, v40
  v_exp_f32 v41, v41
  v_exp_f32 v42, v42
  v_mfma_f32_32x32x16_bf16 v[52:67], v[88:91], v[16:19], v[20:35]
  s_mov_b64 exec, s[38:39]
  ds_read_b128 v[100:103], v4 offset:14336
  ds_read_b128 v[104:107], v4 offset:14848
  s_mov_b64 exec, -1
  v_exp_f32 v43, v43
  v_exp_f32 v44, v44
  v_exp_f32 v45, v45
  v_exp_f32 v46, v46
  v_exp_f32 v47, v47
  v_smfmac_f32_32x32x32_bf16 v[68:83], v[92:95], v[36:43], v108
  v_exp_f32 v48, v48
  v_exp_f32 v49, v49
  v_exp_f32 v50, v50
  v_exp_f32 v51, v51
  s_waitcnt lgkmcnt(0)
  v_exp_f32 v52, v52
  v_exp_f32 v53, v53
  v_exp_f32 v54, v54
  v_smfmac_f32_32x32x32_bf16 v[68:83], v[96:99], v[44:51], v108
  v_exp_f32 v55, v55
  v_exp_f32 v56, v56
  v_exp_f32 v57, v57
  v_exp_f32 v58, v58
  v_exp_f32 v59, v59
  v_exp_f32 v60, v60
  v_exp_f32 v61, v61
  v_exp_f32 v62, v62
  v_exp_f32 v63, v63
  v_smfmac_f32_32x32x32_bf16 v[68:83], v[100:103], v[52:59], v108
  v_exp_f32 v64, v64
  v_exp_f32 v65, v65
  v_exp_f32 v66, v66
  v_exp_f32 v67, v67
  s_waitcnt lgkmcnt(0)
  s_cmp_lt_u32 s32, 4
  s_cbranch_scc1 Lyg_24
  s_mov_b32 s60, 50000
  s_branch Lkp_26
Lkv_25:
  s_waitcnt vmcnt(0)
  v_cmp_eq_u32 vcc, s48, v13
  s_lshr_b32 s21, vcc_lo, 8
  s_and_b32 s29, vcc_lo, s21
  s_and_b32 s29, s29, 0xff
Lkp_26:
  s_cmp_ge_u32 s61, 114688
  s_cbranch_scc1 Lkd_28
  s_andn2_b32 s20, s29, s43
  s_cbranch_scc0 Lkm_27
  s_ff1_i32_b32 s21, s20
  s_bitset1_b32 s43, s21
  s_add_u32 s61, s61, 16384
  s_mov_b32 m0, s61
  s_lshl_b32 s21, s21, 14
  s_add_u32 s21, s21, s28
  s_add_u32 s21, s21, s35
  buffer_load_dwordx4 v9, s[16:19], s21 offen offset:0 sc1 lds
  buffer_load_dwordx4 v9, s[16:19], s21 offen offset:1024 sc1 lds
  buffer_load_dwordx4 v9, s[16:19], s21 offen offset:2048 sc1 lds
  buffer_load_dwordx4 v9, s[16:19], s21 offen offset:3072 sc1 lds
  s_branch Lkp_26
Lkm_27:
  s_cmp_ge_u32 s61, 114688
  s_cbranch_scc1 Lkd_28
  buffer_load_dword v13, v12, s[16:19], s40 offen sc1
  s_sub_u32 s60, s60, 1
  s_cmp_lg_u32 s60, 0
  s_cbranch_scc1 Lkv_25
Lkd_28:
Lyg_24:
  s_waitcnt vmcnt(0)
  s_barrier
  s_cmp_lt_u32 s32, 4
  s_cbranch_scc1 Lpr_29
  s_setprio 1
Lpr_29:
  ds_read_b128 v[84:87], v3 offset:16384
  ds_read_b128 v[88:91], v3 offset:18432
  s_mov_b64 exec, s[38:39]
  ds_read_b128 v[92:95], v4 offset:16384
  ds_read_b128 v[96:99], v4 offset:16896
  s_mov_b64 exec, -1
  s_waitcnt lgkmcnt(3)
  v_mfma_f32_32x32x16_bf16 v[36:51], v[84:87], v[16:19], v[20:35]
  s_waitcnt lgkmcnt(0)
  s_nop 10
  v_exp_f32 v36, v36
  v_exp_f32 v37, v37
  v_exp_f32 v38, v38
  v_smfmac_f32_32x32x32_bf16 v[68:83], v[104:107], v[60:67], v108
  v_exp_f32 v39, v39
  v_exp_f32 v40, v40
  v_exp_f32 v41, v41
  v_exp_f32 v42, v42
  v_mfma_f32_32x32x16_bf16 v[52:67], v[88:91], v[16:19], v[20:35]
  ds_read_b128 v[84:87], v3 offset:20480
  s_mov_b64 exec, s[38:39]
  ds_read_b128 v[100:103], v4 offset:18432
  ds_read_b128 v[104:107], v4 offset:18944
  s_mov_b64 exec, -1
  v_exp_f32 v43, v43
  v_exp_f32 v44, v44
  v_exp_f32 v45, v45
  v_exp_f32 v46, v46
  v_exp_f32 v47, v47
  v_smfmac_f32_32x32x32_bf16 v[68:83], v[92:95], v[36:43], v108
  v_exp_f32 v48, v48
  v_exp_f32 v49, v49
  v_exp_f32 v50, v50
  v_exp_f32 v51, v51
  s_waitcnt lgkmcnt(0)
  s_sub_u32 s20, s32, 1
  s_cmp_gt_u32 s20, 1
  s_cbranch_scc1 Lw12_30
  s_mov_b32 s12, s46
  s_mov_b32 s13, s47
  s_mov_b32 s14, 3145728
  s_mov_b32 s15, 0x20000
  v_mul_u32_u24 v5, 6144, v11
  v_add_u32 v5, v5, v10
  s_lshr_b32 s21, s2, 6
  s_mul_i32 s22, s21, 786432
  s_lshl_b32 s23, s62, 6
  s_add_u32 s22, s22, s23
  s_lshl_b32 s23, s20, 5
  s_add_u32 s22, s22, s23
  s_add_u32 s22, s22, 2048
  s_mov_b32 s23, s36
  s_lshl_b32 s21, s21, 8
  v_lshl_add_u32 v6, v2, 2, s21
  global_load_dword v112, v6, s[44:45]
  s_mov_b32 m0, s23
  s_nop 0
  buffer_load_dwordx4 v5, s[12:15], s22 offen lds
  s_add_u32 s23, s23, 1024
  s_mov_b32 m0, s23
  s_add_u32 s22, s22, 196608
  buffer_load_dwordx4 v5, s[12:15], s22 offen lds
  s_add_u32 s23, s23, 1024
  s_mov_b32 m0, s23
  s_add_u32 s22, s22, 196608
  buffer_load_dwordx4 v5, s[12:15], s22 offen lds
  s_add_u32 s23, s23, 1024
  s_mov_b32 m0, s23
  s_add_u32 s22, s22, 196608
  buffer_load_dwordx4 v5, s[12:15], s22 offen lds
  s_add_u32 s23, s23, 1024
Lw12_30:
  s_sub_u32 s20, s32, 2
  s_cmp_gt_u32 s20, 1
  s_cbranch_scc1 Ltw_31
  s_lshr_b32 s21, s2, 3
  s_lshl_b32 s21, s21, 1
  s_add_u32 s20, s20, s21
  s_lshl_b32 s20, s20, 13
  v_lshl_add_u32 v5, v2, 7, s20
  global_load_dword v204, v5, s[10:11]
Ltw_31:
  v_exp_f32 v52, v52
  v_exp_f32 v53, v53
  v_exp_f32 v54, v54
  v_smfmac_f32_32x32x32_bf16 v[68:83], v[96:99], v[44:51], v108
  v_exp_f32 v55, v55
  v_exp_f32 v56, v56
  v_exp_f32 v57, v57
  v_exp_f32 v58, v58
  v_mfma_f32_32x32x16_bf16 v[36:51], v[84:87], v[16:19], v[20:35]
  ds_read_b128 v[88:91], v3 offset:22528
  s_mov_b64 exec, s[38:39]
  ds_read_b128 v[92:95], v4 offset:20480
  ds_read_b128 v[96:99], v4 offset:20992
  s_mov_b64 exec, -1
  v_exp_f32 v59, v59
  v_exp_f32 v60, v60
  v_exp_f32 v61, v61
  v_exp_f32 v62, v62
  v_exp_f32 v63, v63
  v_smfmac_f32_32x32x32_bf16 v[68:83], v[100:103], v[52:59], v108
  v_exp_f32 v64, v64
  v_exp_f32 v65, v65
  v_exp_f32 v66, v66
  v_exp_f32 v67, v67
  s_waitcnt lgkmcnt(0)
  v_exp_f32 v36, v36
  v_exp_f32 v37, v37
  v_exp_f32 v38, v38
  v_smfmac_f32_32x32x32_bf16 v[68:83], v[104:107], v[60:67], v108
  v_exp_f32 v39, v39
  v_exp_f32 v40, v40
  v_exp_f32 v41, v41
  v_exp_f32 v42, v42
  v_mfma_f32_32x32x16_bf16 v[52:67], v[88:91], v[16:19], v[20:35]
  ds_read_b128 v[84:87], v3 offset:24576
  s_mov_b64 exec, s[38:39]
  ds_read_b128 v[100:103], v4 offset:22528
  ds_read_b128 v[104:107], v4 offset:23040
  s_mov_b64 exec, -1
  v_exp_f32 v43, v43
  v_exp_f32 v44, v44
  v_exp_f32 v45, v45
  v_exp_f32 v46, v46
  v_exp_f32 v47, v47
  v_smfmac_f32_32x32x32_bf16 v[68:83], v[92:95], v[36:43], v108
  v_exp_f32 v48, v48
  v_exp_f32 v49, v49
  v_exp_f32 v50, v50
  v_exp_f32 v51, v51
  s_waitcnt lgkmcnt(0)
  v_exp_f32 v52, v52
  v_exp_f32 v53, v53
  v_exp_f32 v54, v54
  v_smfmac_f32_32x32x32_bf16 v[68:83], v[96:99], v[44:51], v108
  v_exp_f32 v55, v55
  v_exp_f32 v56, v56
  v_exp_f32 v57, v57
  v_exp_f32 v58, v58
  v_mfma_f32_32x32x16_bf16 v[36:51], v[84:87], v[16:19], v[20:35]
  ds_read_b128 v[88:91], v3 offset:26624
  s_mov_b64 exec, s[38:39]
  ds_read_b128 v[92:95], v4 offset:24576
  ds_read_b128 v[96:99], v4 offset:25088
  s_mov_b64 exec, -1
  v_exp_f32 v59, v59
  v_exp_f32 v60, v60
  v_exp_f32 v61, v61
  v_exp_f32 v62, v62
  v_exp_f32 v63, v63
  v_smfmac_f32_32x32x32_bf16 v[68:83], v[100:103], v[52:59], v108
  v_exp_f32 v64, v64
  v_exp_f32 v65, v65
  v_exp_f32 v66, v66
  v_exp_f32 v67, v67
  s_waitcnt lgkmcnt(0)
  v_exp_f32 v36, v36
  v_exp_f32 v37, v37
  v_exp_f32 v38, v38
  v_smfmac_f32_32x32x32_bf16 v[68:83], v[104:107], v[60:67], v108
  v_exp_f32 v39, v39
  v_exp_f32 v40, v40
  v_exp_f32 v41, v41
  v_exp_f32 v42, v42
  v_mfma_f32_32x32x16_bf16 v[52:67], v[88:91], v[16:19], v[20:35]
  ds_read_b128 v[84:87], v3 offset:28672
  s_mov_b64 exec, s[38:39]
  ds_read_b128 v[100:103], v4 offset:26624
  ds_read_b128 v[104:107], v4 offset:27136
  s_mov_b64 exec, -1
  v_exp_f32 v43, v43
  v_exp_f32 v44, v44
  v_exp_f32 v45, v45
  v_exp_f32 v46, v46
  v_exp_f32 v47, v47
  v_smfmac_f32_32x32x32_bf16 v[68:83], v[92:95], v[36:43], v108
  v_exp_f32 v48, v48
  v_exp_f32 v49, v49
  v_exp_f32 v50, v50
  v_exp_f32 v51, v51
  s_waitcnt lgkmcnt(0)
  v_exp_f32 v52, v52
  v_exp_f32 v53, v53
  v_exp_f32 v54, v54
  v_smfmac_f32_32x32x32_bf16 v[68:83], v[96:99], v[44:51], v108
  v_exp_f32 v55, v55
  v_exp_f32 v56, v56
  v_exp_f32 v57, v57
  v_exp_f32 v58, v58
  v_mfma_f32_32x32x16_bf16 v[36:51], v[84:87], v[16:19], v[20:35]
  ds_read_b128 v[88:91], v3 offset:30720
  s_mov_b64 exec, s[38:39]
  ds_read_b128 v[92:95], v4 offset:28672
  ds_read_b128 v[96:99], v4 offset:29184
  s_mov_b64 exec, -1
  v_exp_f32 v59, v59
  v_exp_f32 v60, v60
  v_exp_f32 v61, v61
  v_exp_f32 v62, v62
  v_exp_f32 v63, v63
  v_smfmac_f32_32x32x32_bf16 v[68:83], v[100:103], v[52:59], v108
  v_exp_f32 v64, v64
  v_exp_f32 v65, v65
  v_exp_f32 v66, v66
  v_exp_f32 v67, v67
  s_waitcnt lgkmcnt(0)
  s_sub_u32 s20, s32, 1
  s_cmp_gt_u32 s20, 1
  s_cbranch_scc1 Lw12_32
  s_waitcnt vmcnt(0)
  v_lshlrev_b32 v113, 16, v112
  v_and_b32 v112, 0xffff0000, v112
  v_mul_f32 v5, 0xbfb8aa3b, v113
  v_exp_f32 v5, v5
  s_nop 0
  v_add_f32 v5, 1.0, v5
  v_rcp_f32 v5, v5
  s_nop 0
  v_mul_f32 v113, v113, v5
  v_mul_f32 v5, 0xbfb8aa3b, v112
  v_exp_f32 v5, v5
  s_nop 0
  v_add_f32 v5, 1.0, v5
  v_rcp_f32 v5, v5
  s_nop 0
  v_mul_f32 v112, v112, v5
  ds_read_b64_tr_b16 v[132:133], v14 offset:0
  ds_read_b64_tr_b16 v[134:135], v15 offset:0
  ds_read_b64_tr_b16 v[136:137], v14 offset:1024
  ds_read_b64_tr_b16 v[138:139], v15 offset:1024
  ds_read_b64_tr_b16 v[140:141], v14 offset:2048
  ds_read_b64_tr_b16 v[142:143], v15 offset:2048
  ds_read_b64_tr_b16 v[144:145], v14 offset:3072
  ds_read_b64_tr_b16 v[146:147], v15 offset:3072
  v_cvt_pk_bf16_f32 v112, v113, v112
  v_lshl_add_u32 v5, v2, 2, s36
  ds_write_b32 v5, v112
  v_and_b32 v5, 48, v2
  v_add_u32 v5, s36, v5
  ds_read_b128 v[116:119], v5 offset:0
  ds_read_b128 v[120:123], v5 offset:64
  ds_read_b128 v[124:127], v5 offset:128
  ds_read_b128 v[128:131], v5 offset:192
Lw12_32:
  v_exp_f32 v36, v36
  v_exp_f32 v37, v37
  v_exp_f32 v38, v38
  v_smfmac_f32_32x32x32_bf16 v[68:83], v[104:107], v[60:67], v108
  v_exp_f32 v39, v39
  v_exp_f32 v40, v40
  v_exp_f32 v41, v41
  v_exp_f32 v42, v42
  v_mfma_f32_32x32x16_bf16 v[52:67], v[88:91], v[16:19], v[20:35]
  ds_read_b128 v[84:87], v3 offset:32768
  s_mov_b64 exec, s[38:39]
  ds_read_b128 v[100:103], v4 offset:30720
  ds_read_b128 v[104:107], v4 offset:31232
  s_mov_b64 exec, -1
  v_exp_f32 v43, v43
  v_exp_f32 v44, v44
  v_exp_f32 v45, v45
  v_exp_f32 v46, v46
  v_exp_f32 v47, v47
  v_smfmac_f32_32x32x32_bf16 v[68:83], v[92:95], v[36:43], v108
  v_exp_f32 v48, v48
  v_exp_f32 v49, v49
  v_exp_f32 v50, v50
  v_exp_f32 v51, v51
  s_waitcnt lgkmcnt(0)
  s_sub_u32 s20, s32, 1
  s_cmp_gt_u32 s20, 1
  s_cbranch_scc1 Lw12_33
  v_mfma_f32_16x16x32_bf16 v[112:115], v[116:119], v[132:135], 0
  v_mfma_f32_16x16x32_bf16 v[112:115], v[120:123], v[136:139], v[112:115]
  v_mfma_f32_16x16x32_bf16 v[112:115], v[124:127], v[140:143], v[112:115]
  v_mfma_f32_16x16x32_bf16 v[112:115], v[128:131], v[144:147], v[112:115]
Lw12_33:
  s_cmp_ge_u32 s2, 112
  s_cbranch_scc1 Lms_34
  v_mul_u32_u24 v109, 3584, v11
  v_add_u32 v109, v109, v10
  s_and_b32 s20, s32, 1
  s_cmp_eq_u32 s20, 0
  s_cselect_b32 s24, s54, s56
  s_cselect_b32 s25, s55, s57
  s_mov_b32 s26, 1835008
  s_lshr_b32 s20, s32, 1
  s_mul_i32 s43, s20, 458752
  s_and_b32 s33, s2, 7
  s_mul_i32 s33, s33, 14
  s_lshr_b32 s20, s2, 3
  s_add_u32 s33, s33, s20
  s_lshl_b32 s20, s33, 5
  s_add_u32 s43, s43, s20
  s_mov_b32 s61, 114688
  s_branch Lms_35
Lms_34:
  v_lshl_add_u32 v109, v11, 10, v10
  s_mov_b32 s24, s58
  s_mov_b32 s25, s59
  s_mov_b32 s26, 1835008
  s_mul_i32 s43, s32, 229376
  s_and_b32 s33, s2, 7
  s_lshl_b32 s33, s33, 2
  s_sub_u32 s20, s2, 112
  s_bfe_u32 s20, s20, 0x20003
  s_add_u32 s33, s33, s20
  s_lshl_b32 s20, s33, 5
  s_add_u32 s43, s43, s20
  s_mov_b32 s61, 32768
Lms_35:
  s_sub_u32 s20, s32, 1
  s_cmp_lt_u32 s20, 2
  s_cbranch_scc1 Ln12_36
  s_mov_b32 s12, s10
  s_mov_b32 s13, s11
  s_mov_b32 s14, 524288
  s_mov_b32 s15, 0x20000
  s_mov_b32 m0, s36
  s_mov_b32 s20, 0
  buffer_load_dwordx4 v1, s[12:15], s20 offen offset:0 lds
  s_mov_b32 s20, 31744
  buffer_load_dwordx4 v1, s[12:15], s20 offen offset:1024 lds
  s_mov_b32 s20, 63488
  buffer_load_dwordx4 v1, s[12:15], s20 offen offset:2048 lds
  s_mov_b32 s20, 95232
  buffer_load_dwordx4 v1, s[12:15], s20 offen offset:3072 lds
Ln12_36:
  v_exp_f32 v52, v52
  v_exp_f32 v53, v53
  v_exp_f32 v54, v54
  v_smfmac_f32_32x32x32_bf16 v[68:83], v[96:99], v[44:51], v108
  v_exp_f32 v55, v55
  v_exp_f32 v56, v56
  v_exp_f32 v57, v57
  v_exp_f32 v58, v58
  v_mfma_f32_32x32x16_bf16 v[36:51], v[84:87], v[16:19], v[20:35]
  ds_read_b128 v[88:91], v3 offset:34816
  s_mov_b64 exec, s[38:39]
  ds_read_b128 v[92:95], v4 offset:32768
  ds_read_b128 v[96:99], v4 offset:33280
  s_mov_b64 exec, -1
  v_exp_f32 v59, v59
  v_exp_f32 v60, v60
  v_exp_f32 v61, v61
  v_exp_f32 v62, v62
  v_exp_f32 v63, v63
  v_smfmac_f32_32x32x32_bf16 v[68:83], v[100:103], v[52:59], v108
  v_exp_f32 v64, v64
  v_exp_f32 v65, v65
  v_exp_f32 v66, v66
  v_exp_f32 v67, v67
  v_add_u32 v3, 0x8000, v3
  v_add_u32 v4, 0x8000, v4
  s_waitcnt lgkmcnt(0)
  s_sub_u32 s20, s32, 1
  s_cmp_gt_u32 s20, 1
  s_cbranch_scc1 Lw12_37
  s_lshr_b32 s21, s2, 6
  s_lshl_b32 s21, s21, 14
  s_lshl_b32 s22, s62, 8
  s_add_u32 s21, s21, s22
  s_lshl_b32 s22, s20, 7
  s_add_u32 s21, s21, s22
  s_add_u32 s21, s21, 131072
  v_lshlrev_b32 v5, 3, v2
  v_mov_b32 v113, s48
  s_mov_b64 exec, 0xffff
  buffer_store_dwordx2 v[112:113], v5, s[16:19], s21 offen sc1
  s_mov_b64 exec, -1
Lw12_37:
  s_cmp_lt_u32 s2, 144
  s_cbranch_scc1 Ltc_38
  s_cmp_gt_u32 s32, 1
  s_cbranch_scc1 Ltc_38
  s_sub_u32 s20, s2, 144
  s_lshr_b32 s20, s20, 3
  s_lshl_b32 s20, s20, 1
  s_add_u32 s20, s20, s32
  s_lshl_b32 s20, s20, 16
  s_and_b32 s21, s2, 7
  s_lshl_b32 s21, s21, 7
  s_add_u32 s20, s20, s21
  v_lshl_add_u32 v5, v2, 10, s20
  global_load_dword v204, v5, s[58:59]
Ltc_38:
  v_exp_f32 v36, v36
  v_exp_f32 v37, v37
  v_exp_f32 v38, v38
  v_smfmac_f32_32x32x32_bf16 v[68:83], v[104:107], v[60:67], v108
  v_exp_f32 v39, v39
  v_exp_f32 v40, v40
  v_exp_f32 v41, v41
  v_exp_f32 v42, v42
  v_mfma_f32_32x32x16_bf16 v[52:67], v[88:91], v[16:19], v[20:35]
  ds_read_b128 v[84:87], v3 offset:4096
  s_mov_b64 exec, s[38:39]
  ds_read_b128 v[100:103], v4 offset:2048
  ds_read_b128 v[104:107], v4 offset:2560
  s_mov_b64 exec, -1
  v_exp_f32 v43, v43
  v_exp_f32 v44, v44
  v_exp_f32 v45, v45
  v_exp_f32 v46, v46
  v_exp_f32 v47, v47
  v_smfmac_f32_32x32x32_bf16 v[68:83], v[92:95], v[36:43], v108
  v_exp_f32 v48, v48
  v_exp_f32 v49, v49
  v_exp_f32 v50, v50
  v_exp_f32 v51, v51
  s_waitcnt lgkmcnt(0)
  s_sub_u32 s20, s32, 1
  s_cmp_gt_u32 s20, 1
  s_cbranch_scc1 Lw12_39
  s_mov_b32 s12, s10
  s_mov_b32 s13, s11
  s_mov_b32 s14, 524288
  s_mov_b32 s15, 0x20000
  s_mov_b32 m0, s36
  s_mov_b32 s20, 0
  buffer_load_dwordx4 v1, s[12:15], s20 offen offset:0 lds
  s_mov_b32 s20, 31744
  buffer_load_dwordx4 v1, s[12:15], s20 offen offset:1024 lds
  s_mov_b32 s20, 63488
  buffer_load_dwordx4 v1, s[12:15], s20 offen offset:2048 lds
  s_mov_b32 s20, 95232
  buffer_load_dwordx4 v1, s[12:15], s20 offen offset:3072 lds
Lw12_39:
  v_exp_f32 v52, v52
  v_exp_f32 v53, v53
  v_exp_f32 v54, v54
  v_smfmac_f32_32x32x32_bf16 v[68:83], v[96:99], v[44:51], v108
  v_exp_f32 v55, v55
  v_exp_f32 v56, v56
  v_exp_f32 v57, v57
  v_exp_f32 v58, v58
  v_mfma_f32_32x32x16_bf16 v[36:51], v[84:87], v[16:19], v[20:35]
  ds_read_b128 v[88:91], v3 offset:6144
  s_mov_b64 exec, s[38:39]
  ds_read_b128 v[92:95], v4 offset:4096
  ds_read_b128 v[96:99], v4 offset:4608
  s_mov_b64 exec, -1
  v_exp_f32 v59, v59
  v_exp_f32 v60, v60
  v_exp_f32 v61, v61
  v_exp_f32 v62, v62
  v_exp_f32 v63, v63
  v_smfmac_f32_32x32x32_bf16 v[68:83], v[100:103], v[52:59], v108
  v_exp_f32 v64, v64
  v_exp_f32 v65, v65
  v_exp_f32 v66, v66
  v_exp_f32 v67, v67
  s_waitcnt lgkmcnt(0)
  v_exp_f32 v36, v36
  v_exp_f32 v37, v37
  v_exp_f32 v38, v38
  v_smfmac_f32_32x32x32_bf16 v[68:83], v[104:107], v[60:67], v108
  v_exp_f32 v39, v39
  v_exp_f32 v40, v40
  v_exp_f32 v41, v41
  v_exp_f32 v42, v42
  v_mfma_f32_32x32x16_bf16 v[52:67], v[88:91], v[16:19], v[20:35]
  ds_read_b128 v[84:87], v3 offset:8192
  s_mov_b64 exec, s[38:39]
  ds_read_b128 v[100:103], v4 offset:6144
  ds_read_b128 v[104:107], v4 offset:6656
  s_mov_b64 exec, -1
  v_exp_f32 v43, v43
  v_exp_f32 v44, v44
  v_exp_f32 v45, v45
  v_exp_f32 v46, v46
  v_exp_f32 v47, v47
  v_smfmac_f32_32x32x32_bf16 v[68:83], v[92:95], v[36:43], v108
  v_exp_f32 v48, v48
  v_exp_f32 v49, v49
  v_exp_f32 v50, v50
  v_exp_f32 v51, v51
  s_waitcnt lgkmcnt(0)
  v_exp_f32 v52, v52
  v_exp_f32 v53, v53
  v_exp_f32 v54, v54
  v_smfmac_f32_32x32x32_bf16 v[68:83], v[96:99], v[44:51], v108
  v_exp_f32 v55, v55
  v_exp_f32 v56, v56
  v_exp_f32 v57, v57
  v_exp_f32 v58, v58
  v_mfma_f32_32x32x16_bf16 v[36:51], v[84:87], v[16:19], v[20:35]
  ds_read_b128 v[88:91], v3 offset:10240
  s_mov_b64 exec, s[38:39]
  ds_read_b128 v[92:95], v4 offset:8192
  ds_read_b128 v[96:99], v4 offset:8704
  s_mov_b64 exec, -1
  v_exp_f32 v59, v59
  v_exp_f32 v60, v60
  v_exp_f32 v61, v61
  v_exp_f32 v62, v62
  v_exp_f32 v63, v63
  v_smfmac_f32_32x32x32_bf16 v[68:83], v[100:103], v[52:59], v108
  v_exp_f32 v64, v64
  v_exp_f32 v65, v65
  v_exp_f32 v66, v66
  v_exp_f32 v67, v67
  s_waitcnt lgkmcnt(0)
  v_exp_f32 v36, v36
  v_exp_f32 v37, v37
  v_exp_f32 v38, v38
  v_smfmac_f32_32x32x32_bf16 v[68:83], v[104:107], v[60:67], v108
  v_exp_f32 v39, v39
  v_exp_f32 v40, v40
  v_exp_f32 v41, v41
  v_exp_f32 v42, v42
  v_mfma_f32_32x32x16_bf16 v[52:67], v[88:91], v[16:19], v[20:35]
  ds_read_b128 v[84:87], v3 offset:12288
  s_mov_b64 exec, s[38:39]
  ds_read_b128 v[100:103], v4 offset:10240
  ds_read_b128 v[104:107], v4 offset:10752
  s_mov_b64 exec, -1
  v_exp_f32 v43, v43
  v_exp_f32 v44, v44
  v_exp_f32 v45, v45
  v_exp_f32 v46, v46
  v_exp_f32 v47, v47
  v_smfmac_f32_32x32x32_bf16 v[68:83], v[92:95], v[36:43], v108
  v_exp_f32 v48, v48
  v_exp_f32 v49, v49
  v_exp_f32 v50, v50
  v_exp_f32 v51, v51
  s_waitcnt lgkmcnt(0)
  v_exp_f32 v52, v52
  v_exp_f32 v53, v53
  v_exp_f32 v54, v54
  v_smfmac_f32_32x32x32_bf16 v[68:83], v[96:99], v[44:51], v108
  v_exp_f32 v55, v55
  v_exp_f32 v56, v56
  v_exp_f32 v57, v57
  v_exp_f32 v58, v58
  v_mfma_f32_32x32x16_bf16 v[36:51], v[84:87], v[16:19], v[20:35]
  ds_read_b128 v[88:91], v3 offset:14336
  s_mov_b64 exec, s[38:39]
  ds_read_b128 v[92:95], v4 offset:12288
  ds_read_b128 v[96:99], v4 offset:12800
  s_mov_b64 exec, -1
  v_exp_f32 v59, v59
  v_exp_f32 v60, v60
  v_exp_f32 v61, v61
  v_exp_f32 v62, v62
  v_exp_f32 v63, v63
  v_smfmac_f32_32x32x32_bf16 v[68:83], v[100:103], v[52:59], v108
  v_exp_f32 v64, v64
  v_exp_f32 v65, v65
  v_exp_f32 v66, v66
  v_exp_f32 v67, v67
  s_waitcnt lgkmcnt(0)
  v_exp_f32 v36, v36
  v_exp_f32 v37, v37
  v_exp_f32 v38, v38
  v_smfmac_f32_32x32x32_bf16 v[68:83], v[104:107], v[60:67], v108
  v_exp_f32 v39, v39
  v_exp_f32 v40, v40
  v_exp_f32 v41, v41
  v_exp_f32 v42, v42
  v_mfma_f32_32x32x16_bf16 v[52:67], v[88:91], v[16:19], v[20:35]
  ds_read_b128 v[84:87], v3 offset:16384
  s_mov_b64 exec, s[38:39]
  ds_read_b128 v[100:103], v4 offset:14336
  ds_read_b128 v[104:107], v4 offset:14848
  s_mov_b64 exec, -1
  v_exp_f32 v43, v43
  v_exp_f32 v44, v44
  v_exp_f32 v45, v45
  v_exp_f32 v46, v46
  v_exp_f32 v47, v47
  v_smfmac_f32_32x32x32_bf16 v[68:83], v[92:95], v[36:43], v108
  v_exp_f32 v48, v48
  v_exp_f32 v49, v49
  v_exp_f32 v50, v50
  v_exp_f32 v51, v51
  s_waitcnt lgkmcnt(0)
  v_exp_f32 v52, v52
  v_exp_f32 v53, v53
  v_exp_f32 v54, v54
  v_smfmac_f32_32x32x32_bf16 v[68:83], v[96:99], v[44:51], v108
  v_exp_f32 v55, v55
  v_exp_f32 v56, v56
  v_exp_f32 v57, v57
  v_exp_f32 v58, v58
  v_mfma_f32_32x32x16_bf16 v[36:51], v[84:87], v[16:19], v[20:35]
  ds_read_b128 v[88:91], v3 offset:18432
  s_mov_b64 exec, s[38:39]
  ds_read_b128 v[92:95], v4 offset:16384
  ds_read_b128 v[96:99], v4 offset:16896
  s_mov_b64 exec, -1
  v_exp_f32 v59, v59
  v_exp_f32 v60, v60
  v_exp_f32 v61, v61
  v_exp_f32 v62, v62
  v_exp_f32 v63, v63
  v_smfmac_f32_32x32x32_bf16 v[68:83], v[100:103], v[52:59], v108
  v_exp_f32 v64, v64
  v_exp_f32 v65, v65
  v_exp_f32 v66, v66
  v_exp_f32 v67, v67
  s_waitcnt lgkmcnt(0)
  s_waitcnt vmcnt(0)
  ds_read_b64_tr_b16 v[112:113], v110 offset:0
  ds_read_b64_tr_b16 v[114:115], v110 offset:256
  ds_read_b64_tr_b16 v[116:117], v110 offset:1024
  ds_read_b64_tr_b16 v[118:119], v110 offset:1280
  ds_read_b64_tr_b16 v[120:121], v110 offset:2048
  ds_read_b64_tr_b16 v[122:123], v110 offset:2304
  ds_read_b64_tr_b16 v[124:125], v110 offset:3072
  ds_read_b64_tr_b16 v[126:127], v110 offset:3328
  v_exp_f32 v36, v36
  v_exp_f32 v37, v37
  v_exp_f32 v38, v38
  v_smfmac_f32_32x32x32_bf16 v[68:83], v[104:107], v[60:67], v108
  v_exp_f32 v39, v39
  v_exp_f32 v40, v40
  v_exp_f32 v41, v41
  v_exp_f32 v42, v42
  v_mfma_f32_32x32x16_bf16 v[52:67], v[88:91], v[16:19], v[20:35]
  ds_read_b128 v[84:87], v3 offset:20480
  s_mov_b64 exec, s[38:39]
  ds_read_b128 v[100:103], v4 offset:18432
  ds_read_b128 v[104:107], v4 offset:18944
  s_mov_b64 exec, -1
  v_exp_f32 v43, v43
  v_exp_f32 v44, v44
  v_exp_f32 v45, v45
  v_exp_f32 v46, v46
  v_exp_f32 v47, v47
  v_smfmac_f32_32x32x32_bf16 v[68:83], v[92:95], v[36:43], v108
  v_exp_f32 v48, v48
  v_exp_f32 v49, v49
  v_exp_f32 v50, v50
  v_exp_f32 v51, v51
  s_waitcnt lgkmcnt(0)
  s_mov_b32 m0, s36
  s_mov_b32 s20, 131072
  buffer_load_dwordx4 v1, s[12:15], s20 offen offset:0 lds
  s_mov_b32 s20, 162816
  buffer_load_dwordx4 v1, s[12:15], s20 offen offset:1024 lds
  s_mov_b32 s20, 194560
  buffer_load_dwordx4 v1, s[12:15], s20 offen offset:2048 lds
  s_mov_b32 s20, 226304
  buffer_load_dwordx4 v1, s[12:15], s20 offen offset:3072 lds
  s_xor_b32 s20, s48, 0x80000000
  v_mov_b32 v5, s20
  v_lshlrev_b32 v6, 2, v2
  s_lshl_b32 s21, s41, 12
  s_lshl_b32 s22, s42, 10
  s_add_u32 s21, s21, s22
  s_lshl_b32 s22, s32, 7
  s_add_u32 s21, s21, s22
  s_add_u32 s21, s21, 1572864
  s_mov_b32 exec_hi, 0
  buffer_store_dword v5, v6, s[16:19], s21 offen sc1
  s_lshl_b32 s21, s34, 12
  s_lshl_b32 s22, s30, 7
  s_add_u32 s21, s21, s22
  s_add_u32 s21, s21, 1310720
  buffer_store_dword v5, v6, s[16:19], s21 offen sc1
  s_or_b32 s20, s42, s32
  s_cbranch_scc1 Lpw_42
  s_lshl_b32 s21, s41, 7
  s_add_u32 s21, s21, 393216
  buffer_store_dword v5, v6, s[16:19], s21 offen sc1
Lpw_42:
  s_mov_b64 exec, -1
  v_exp_f32 v52, v52
  v_exp_f32 v53, v53
  v_exp_f32 v54, v54
  v_smfmac_f32_32x32x32_bf16 v[68:83], v[96:99], v[44:51], v108
  v_exp_f32 v55, v55
  v_exp_f32 v56, v56
  v_exp_f32 v57, v57
  v_exp_f32 v58, v58
  v_mfma_f32_32x32x16_bf16 v[36:51], v[84:87], v[16:19], v[20:35]
  ds_read_b128 v[88:91], v3 offset:22528
  s_mov_b64 exec, s[38:39]
  ds_read_b128 v[92:95], v4 offset:20480
  ds_read_b128 v[96:99], v4 offset:20992
  s_mov_b64 exec, -1
  v_exp_f32 v59, v59
  v_exp_f32 v60, v60
  v_exp_f32 v61, v61
  v_exp_f32 v62, v62
  v_exp_f32 v63, v63
  v_smfmac_f32_32x32x32_bf16 v[68:83], v[100:103], v[52:59], v108
  v_exp_f32 v64, v64
  v_exp_f32 v65, v65
  v_exp_f32 v66, v66
  v_exp_f32 v67, v67
  s_waitcnt lgkmcnt(0)
  v_exp_f32 v36, v36
  v_exp_f32 v37, v37
  v_exp_f32 v38, v38
  v_smfmac_f32_32x32x32_bf16 v[68:83], v[104:107], v[60:67], v108
  v_exp_f32 v39, v39
  v_exp_f32 v40, v40
  v_exp_f32 v41, v41
  v_exp_f32 v42, v42
  v_mfma_f32_32x32x16_bf16 v[52:67], v[88:91], v[16:19], v[20:35]
  ds_read_b128 v[84:87], v3 offset:24576
  s_mov_b64 exec, s[38:39]
  ds_read_b128 v[100:103], v4 offset:22528
  ds_read_b128 v[104:107], v4 offset:23040
  s_mov_b64 exec, -1
  v_exp_f32 v43, v43
  v_exp_f32 v44, v44
  v_exp_f32 v45, v45
  v_exp_f32 v46, v46
  v_exp_f32 v47, v47
  v_smfmac_f32_32x32x32_bf16 v[68:83], v[92:95], v[36:43], v108
  v_exp_f32 v48, v48
  v_exp_f32 v49, v49
  v_exp_f32 v50, v50
  v_exp_f32 v51, v51
  s_waitcnt lgkmcnt(0)
  s_cmp_ge_u32 s2, 144
  s_cbranch_scc1 Lmd_43
  buffer_load_dwordx4 v[176:179], v109, s[24:27], s43 offen
  s_add_u32 s43, s43, s61
Lmd_43:
  v_exp_f32 v52, v52
  v_exp_f32 v53, v53
  v_exp_f32 v54, v54
  v_smfmac_f32_32x32x32_bf16 v[68:83], v[96:99], v[44:51], v108
  v_exp_f32 v55, v55
  v_exp_f32 v56, v56
  v_exp_f32 v57, v57
  v_exp_f32 v58, v58
  v_mfma_f32_32x32x16_bf16 v[36:51], v[84:87], v[16:19], v[20:35]
  ds_read_b128 v[88:91], v3 offset:26624
  s_mov_b64 exec, s[38:39]
  ds_read_b128 v[92:95], v4 offset:24576
  ds_read_b128 v[96:99], v4 offset:25088
  s_mov_b64 exec, -1
  v_exp_f32 v59, v59
  v_exp_f32 v60, v60
  v_exp_f32 v61, v61
  v_exp_f32 v62, v62
  v_exp_f32 v63, v63
  v_smfmac_f32_32x32x32_bf16 v[68:83], v[100:103], v[52:59], v108
  v_exp_f32 v64, v64
  v_exp_f32 v65, v65
  v_exp_f32 v66, v66
  v_exp_f32 v67, v67
  s_waitcnt lgkmcnt(0)
  v_exp_f32 v36, v36
  v_exp_f32 v37, v37
  v_exp_f32 v38, v38
  v_smfmac_f32_32x32x32_bf16 v[68:83], v[104:107], v[60:67], v108
  v_exp_f32 v39, v39
  v_exp_f32 v40, v40
  v_exp_f32 v41, v41
  v_exp_f32 v42, v42
  v_mfma_f32_32x32x16_bf16 v[52:67], v[88:91], v[16:19], v[20:35]
  ds_read_b128 v[84:87], v3 offset:28672
  s_mov_b64 exec, s[38:39]
  ds_read_b128 v[100:103], v4 offset:26624
  ds_read_b128 v[104:107], v4 offset:27136
  s_mov_b64 exec, -1
  v_exp_f32 v43, v43
  v_exp_f32 v44, v44
  v_exp_f32 v45, v45
  v_exp_f32 v46, v46
  v_exp_f32 v47, v47
  v_smfmac_f32_32x32x32_bf16 v[68:83], v[92:95], v[36:43], v108
  v_exp_f32 v48, v48
  v_exp_f32 v49, v49
  v_exp_f32 v50, v50
  v_exp_f32 v51, v51
  s_waitcnt lgkmcnt(0)
  v_exp_f32 v52, v52
  v_exp_f32 v53, v53
  v_exp_f32 v54, v54
  v_smfmac_f32_32x32x32_bf16 v[68:83], v[96:99], v[44:51], v108
  v_exp_f32 v55, v55
  v_exp_f32 v56, v56
  v_exp_f32 v57, v57
  v_exp_f32 v58, v58
  v_mfma_f32_32x32x16_bf16 v[36:51], v[84:87], v[16:19], v[20:35]
  ds_read_b128 v[88:91], v3 offset:30720
  s_mov_b64 exec, s[38:39]
  ds_read_b128 v[92:95], v4 offset:28672
  ds_read_b128 v[96:99], v4 offset:29184
  s_mov_b64 exec, -1
  v_exp_f32 v59, v59
  v_exp_f32 v60, v60
  v_exp_f32 v61, v61
  v_exp_f32 v62, v62
  v_exp_f32 v63, v63
  v_smfmac_f32_32x32x32_bf16 v[68:83], v[100:103], v[52:59], v108
  v_exp_f32 v64, v64
  v_exp_f32 v65, v65
  v_exp_f32 v66, v66
  v_exp_f32 v67, v67
  s_waitcnt lgkmcnt(0)
  s_cmp_ge_u32 s2, 144
  s_cbranch_scc1 Lmd_44
  buffer_load_dwordx4 v[180:183], v109, s[24:27], s43 offen
  s_add_u32 s43, s43, s61
Lmd_44:
  v_exp_f32 v36, v36
  v_exp_f32 v37, v37
  v_exp_f32 v38, v38
  v_smfmac_f32_32x32x32_bf16 v[68:83], v[104:107], v[60:67], v108
  v_exp_f32 v39, v39
  v_exp_f32 v40, v40
  v_exp_f32 v41, v41
  v_exp_f32 v42, v42
  v_mfma_f32_32x32x16_bf16 v[52:67], v[88:91], v[16:19], v[20:35]
  ds_read_b128 v[84:87], v3 offset:32768
  s_mov_b64 exec, s[38:39]
  ds_read_b128 v[100:103], v4 offset:30720
  ds_read_b128 v[104:107], v4 offset:31232
  s_mov_b64 exec, -1
  v_exp_f32 v43, v43
  v_exp_f32 v44, v44
  v_exp_f32 v45, v45
  v_exp_f32 v46, v46
  v_exp_f32 v47, v47
  v_smfmac_f32_32x32x32_bf16 v[68:83], v[92:95], v[36:43], v108
  v_exp_f32 v48, v48
  v_exp_f32 v49, v49
  v_exp_f32 v50, v50
  v_exp_f32 v51, v51
  s_waitcnt lgkmcnt(0)
  v_exp_f32 v52, v52
  v_exp_f32 v53, v53
  v_exp_f32 v54, v54
  v_smfmac_f32_32x32x32_bf16 v[68:83], v[96:99], v[44:51], v108
  v_exp_f32 v55, v55
  v_exp_f32 v56, v56
  v_exp_f32 v57, v57
  v_exp_f32 v58, v58
  v_mfma_f32_32x32x16_bf16 v[36:51], v[84:87], v[16:19], v[20:35]
  ds_read_b128 v[88:91], v3 offset:34816
  s_mov_b64 exec, s[38:39]
  ds_read_b128 v[92:95], v4 offset:32768
  ds_read_b128 v[96:99], v4 offset:33280
  s_mov_b64 exec, -1
  v_exp_f32 v59, v59
  v_exp_f32 v60, v60
  v_exp_f32 v61, v61
  v_exp_f32 v62, v62
  v_exp_f32 v63, v63
  v_smfmac_f32_32x32x32_bf16 v[68:83], v[100:103], v[52:59], v108
  v_exp_f32 v64, v64
  v_exp_f32 v65, v65
  v_exp_f32 v66, v66
  v_exp_f32 v67, v67
  v_add_u32 v3, 0x8000, v3
  v_add_u32 v4, 0x8000, v4
  s_waitcnt lgkmcnt(0)
  v_exp_f32 v36, v36
  v_exp_f32 v37, v37
  v_exp_f32 v38, v38
  v_smfmac_f32_32x32x32_bf16 v[68:83], v[104:107], v[60:67], v108
  v_exp_f32 v39, v39
  v_exp_f32 v40, v40
  v_exp_f32 v41, v41
  v_exp_f32 v42, v42
  v_mfma_f32_32x32x16_bf16 v[52:67], v[88:91], v[16:19], v[20:35]
  ds_read_b128 v[84:87], v3 offset:4096
  s_mov_b64 exec, s[38:39]
  ds_read_b128 v[100:103], v4 offset:2048
  ds_read_b128 v[104:107], v4 offset:2560
  s_mov_b64 exec, -1
  v_exp_f32 v43, v43
  v_exp_f32 v44, v44
  v_exp_f32 v45, v45
  v_exp_f32 v46, v46
  v_exp_f32 v47, v47
  v_smfmac_f32_32x32x32_bf16 v[68:83], v[92:95], v[36:43], v108
  v_exp_f32 v48, v48
  v_exp_f32 v49, v49
  v_exp_f32 v50, v50
  v_exp_f32 v51, v51
  s_waitcnt lgkmcnt(0)
  v_exp_f32 v52, v52
  v_exp_f32 v53, v53
  v_exp_f32 v54, v54
  v_smfmac_f32_32x32x32_bf16 v[68:83], v[96:99], v[44:51], v108
  v_exp_f32 v55, v55
  v_exp_f32 v56, v56
  v_exp_f32 v57, v57
  v_exp_f32 v58, v58
  v_mfma_f32_32x32x16_bf16 v[36:51], v[84:87], v[16:19], v[20:35]
  ds_read_b128 v[88:91], v3 offset:6144
  s_mov_b64 exec, s[38:39]
  ds_read_b128 v[92:95], v4 offset:4096
  ds_read_b128 v[96:99], v4 offset:4608
  s_mov_b64 exec, -1
  v_exp_f32 v59, v59
  v_exp_f32 v60, v60
  v_exp_f32 v61, v61
  v_exp_f32 v62, v62
  v_exp_f32 v63, v63
  v_smfmac_f32_32x32x32_bf16 v[68:83], v[100:103], v[52:59], v108
  v_exp_f32 v64, v64
  v_exp_f32 v65, v65
  v_exp_f32 v66, v66
  v_exp_f32 v67, v67
  s_waitcnt lgkmcnt(0)
  s_waitcnt vmcnt(2)
  s_sub_u32 s20, s2, 112
  s_cmp_lt_u32 s20, 32
  s_cbranch_scc1 Lww_46
  s_waitcnt vmcnt(2)
  s_cmp_lt_u32 s2, 112
  s_cbranch_scc1 Lww_46
  s_waitcnt vmcnt(0)
Lww_46:
  ds_read_b64_tr_b16 v[128:129], v110 offset:0
  ds_read_b64_tr_b16 v[130:131], v110 offset:256
  ds_read_b64_tr_b16 v[132:133], v110 offset:1024
  ds_read_b64_tr_b16 v[134:135], v110 offset:1280
  ds_read_b64_tr_b16 v[136:137], v110 offset:2048
  ds_read_b64_tr_b16 v[138:139], v110 offset:2304
  ds_read_b64_tr_b16 v[140:141], v110 offset:3072
  ds_read_b64_tr_b16 v[142:143], v110 offset:3328
  v_exp_f32 v36, v36
  v_exp_f32 v37, v37
  v_exp_f32 v38, v38
  v_smfmac_f32_32x32x32_bf16 v[68:83], v[104:107], v[60:67], v108
  v_exp_f32 v39, v39
  v_exp_f32 v40, v40
  v_exp_f32 v41, v41
  v_exp_f32 v42, v42
  v_mfma_f32_32x32x16_bf16 v[52:67], v[88:91], v[16:19], v[20:35]
  ds_read_b128 v[84:87], v3 offset:8192
  s_mov_b64 exec, s[38:39]
  ds_read_b128 v[100:103], v4 offset:6144
  ds_read_b128 v[104:107], v4 offset:6656
  s_mov_b64 exec, -1
  v_exp_f32 v43, v43
  v_exp_f32 v44, v44
  v_exp_f32 v45, v45
  v_exp_f32 v46, v46
  v_exp_f32 v47, v47
  v_smfmac_f32_32x32x32_bf16 v[68:83], v[92:95], v[36:43], v108
  v_exp_f32 v48, v48
  v_exp_f32 v49, v49
  v_exp_f32 v50, v50
  v_exp_f32 v51, v51
  s_waitcnt lgkmcnt(0)
  s_mov_b32 m0, s36
  s_mov_b32 s20, 262144
  buffer_load_dwordx4 v1, s[12:15], s20 offen offset:0 lds
  s_mov_b32 s20, 293888
  buffer_load_dwordx4 v1, s[12:15], s20 offen offset:1024 lds
  s_mov_b32 s20, 325632
  buffer_load_dwordx4 v1, s[12:15], s20 offen offset:2048 lds
  s_mov_b32 s20, 357376
  buffer_load_dwordx4 v1, s[12:15], s20 offen offset:3072 lds
  v_exp_f32 v52, v52
  v_exp_f32 v53, v53
  v_exp_f32 v54, v54
  v_smfmac_f32_32x32x32_bf16 v[68:83], v[96:99], v[44:51], v108
  v_exp_f32 v55, v55
  v_exp_f32 v56, v56
  v_exp_f32 v57, v57
  v_exp_f32 v58, v58
  v_mfma_f32_32x32x16_bf16 v[36:51], v[84:87], v[16:19], v[20:35]
  ds_read_b128 v[88:91], v3 offset:10240
  s_mov_b64 exec, s[38:39]
  ds_read_b128 v[92:95], v4 offset:8192
  ds_read_b128 v[96:99], v4 offset:8704
  s_mov_b64 exec, -1
  v_exp_f32 v59, v59
  v_exp_f32 v60, v60
  v_exp_f32 v61, v61
  v_exp_f32 v62, v62
  v_exp_f32 v63, v63
  v_smfmac_f32_32x32x32_bf16 v[68:83], v[100:103], v[52:59], v108
  v_exp_f32 v64, v64
  v_exp_f32 v65, v65
  v_exp_f32 v66, v66
  v_exp_f32 v67, v67
  s_waitcnt lgkmcnt(0)
  v_exp_f32 v36, v36
  v_exp_f32 v37, v37
  v_exp_f32 v38, v38
  v_smfmac_f32_32x32x32_bf16 v[68:83], v[104:107], v[60:67], v108
  v_exp_f32 v39, v39
  v_exp_f32 v40, v40
  v_exp_f32 v41, v41
  v_exp_f32 v42, v42
  v_mfma_f32_32x32x16_bf16 v[52:67], v[88:91], v[16:19], v[20:35]
  ds_read_b128 v[84:87], v3 offset:12288
  s_mov_b64 exec, s[38:39]
  ds_read_b128 v[100:103], v4 offset:10240
  ds_read_b128 v[104:107], v4 offset:10752
  s_mov_b64 exec, -1
  v_exp_f32 v43, v43
  v_exp_f32 v44, v44
  v_exp_f32 v45, v45
  v_exp_f32 v46, v46
  v_exp_f32 v47, v47
  v_smfmac_f32_32x32x32_bf16 v[68:83], v[92:95], v[36:43], v108
  v_exp_f32 v48, v48
  v_exp_f32 v49, v49
  v_exp_f32 v50, v50
  v_exp_f32 v51, v51
  s_waitcnt lgkmcnt(0)
  s_cmp_ge_u32 s2, 144
  s_cbranch_scc1 Lmd_47
  buffer_load_dwordx4 v[184:187], v109, s[24:27], s43 offen
  s_add_u32 s43, s43, s61
Lmd_47:
  v_exp_f32 v52, v52
  v_exp_f32 v53, v53
  v_exp_f32 v54, v54
  v_smfmac_f32_32x32x32_bf16 v[68:83], v[96:99], v[44:51], v108
  v_exp_f32 v55, v55
  v_exp_f32 v56, v56
  v_exp_f32 v57, v57
  v_exp_f32 v58, v58
  v_mfma_f32_32x32x16_bf16 v[36:51], v[84:87], v[16:19], v[20:35]
  ds_read_b128 v[88:91], v3 offset:14336
  s_mov_b64 exec, s[38:39]
  ds_read_b128 v[92:95], v4 offset:12288
  ds_read_b128 v[96:99], v4 offset:12800
  s_mov_b64 exec, -1
  v_exp_f32 v59, v59
  v_exp_f32 v60, v60
  v_exp_f32 v61, v61
  v_exp_f32 v62, v62
  v_exp_f32 v63, v63
  v_smfmac_f32_32x32x32_bf16 v[68:83], v[100:103], v[52:59], v108
  v_exp_f32 v64, v64
  v_exp_f32 v65, v65
  v_exp_f32 v66, v66
  v_exp_f32 v67, v67
  s_waitcnt lgkmcnt(0)
  v_exp_f32 v36, v36
  v_exp_f32 v37, v37
  v_exp_f32 v38, v38
  v_smfmac_f32_32x32x32_bf16 v[68:83], v[104:107], v[60:67], v108
  v_exp_f32 v39, v39
  v_exp_f32 v40, v40
  v_exp_f32 v41, v41
  v_exp_f32 v42, v42
  v_mfma_f32_32x32x16_bf16 v[52:67], v[88:91], v[16:19], v[20:35]
  ds_read_b128 v[84:87], v3 offset:16384
  s_mov_b64 exec, s[38:39]
  ds_read_b128 v[100:103], v4 offset:14336
  ds_read_b128 v[104:107], v4 offset:14848
  s_mov_b64 exec, -1
  v_exp_f32 v43, v43
  v_exp_f32 v44, v44
  v_exp_f32 v45, v45
  v_exp_f32 v46, v46
  v_exp_f32 v47, v47
  v_smfmac_f32_32x32x32_bf16 v[68:83], v[92:95], v[36:43], v108
  v_exp_f32 v48, v48
  v_exp_f32 v49, v49
  v_exp_f32 v50, v50
  v_exp_f32 v51, v51
  s_waitcnt lgkmcnt(0)
  v_exp_f32 v52, v52
  v_exp_f32 v53, v53
  v_exp_f32 v54, v54
  v_smfmac_f32_32x32x32_bf16 v[68:83], v[96:99], v[44:51], v108
  v_exp_f32 v55, v55
  v_exp_f32 v56, v56
  v_exp_f32 v57, v57
  v_exp_f32 v58, v58
  v_mfma_f32_32x32x16_bf16 v[36:51], v[84:87], v[16:19], v[20:35]
  ds_read_b128 v[88:91], v3 offset:18432
  s_mov_b64 exec, s[38:39]
  ds_read_b128 v[92:95], v4 offset:16384
  ds_read_b128 v[96:99], v4 offset:16896
  s_mov_b64 exec, -1
  v_exp_f32 v59, v59
  v_exp_f32 v60, v60
  v_exp_f32 v61, v61
  v_exp_f32 v62, v62
  v_exp_f32 v63, v63
  v_smfmac_f32_32x32x32_bf16 v[68:83], v[100:103], v[52:59], v108
  v_exp_f32 v64, v64
  v_exp_f32 v65, v65
  v_exp_f32 v66, v66
  v_exp_f32 v67, v67
  s_waitcnt lgkmcnt(0)
  s_cmp_ge_u32 s2, 144
  s_cbranch_scc1 Lmd_48
  buffer_load_dwordx4 v[188:191], v109, s[24:27], s43 offen
  s_add_u32 s43, s43, s61
Lmd_48:
  v_exp_f32 v36, v36
  v_exp_f32 v37, v37
  v_exp_f32 v38, v38
  v_smfmac_f32_32x32x32_bf16 v[68:83], v[104:107], v[60:67], v108
  v_exp_f32 v39, v39
  v_exp_f32 v40, v40
  v_exp_f32 v41, v41
  v_exp_f32 v42, v42
  v_mfma_f32_32x32x16_bf16 v[52:67], v[88:91], v[16:19], v[20:35]
  ds_read_b128 v[84:87], v3 offset:20480
  s_mov_b64 exec, s[38:39]
  ds_read_b128 v[100:103], v4 offset:18432
  ds_read_b128 v[104:107], v4 offset:18944
  s_mov_b64 exec, -1
  v_exp_f32 v43, v43
  v_exp_f32 v44, v44
  v_exp_f32 v45, v45
  v_exp_f32 v46, v46
  v_exp_f32 v47, v47
  v_smfmac_f32_32x32x32_bf16 v[68:83], v[92:95], v[36:43], v108
  v_exp_f32 v48, v48
  v_exp_f32 v49, v49
  v_exp_f32 v50, v50
  v_exp_f32 v51, v51
  s_waitcnt lgkmcnt(0)
  v_exp_f32 v52, v52
  v_exp_f32 v53, v53
  v_exp_f32 v54, v54
  v_smfmac_f32_32x32x32_bf16 v[68:83], v[96:99], v[44:51], v108
  v_exp_f32 v55, v55
  v_exp_f32 v56, v56
  v_exp_f32 v57, v57
  v_exp_f32 v58, v58
  v_mfma_f32_32x32x16_bf16 v[36:51], v[84:87], v[16:19], v[20:35]
  ds_read_b128 v[88:91], v3 offset:22528
  s_mov_b64 exec, s[38:39]
  ds_read_b128 v[92:95], v4 offset:20480
  ds_read_b128 v[96:99], v4 offset:20992
  s_mov_b64 exec, -1
  v_exp_f32 v59, v59
  v_exp_f32 v60, v60
  v_exp_f32 v61, v61
  v_exp_f32 v62, v62
  v_exp_f32 v63, v63
  v_smfmac_f32_32x32x32_bf16 v[68:83], v[100:103], v[52:59], v108
  v_exp_f32 v64, v64
  v_exp_f32 v65, v65
  v_exp_f32 v66, v66
  v_exp_f32 v67, v67
  s_waitcnt lgkmcnt(0)
  v_exp_f32 v36, v36
  v_exp_f32 v37, v37
  v_exp_f32 v38, v38
  v_smfmac_f32_32x32x32_bf16 v[68:83], v[104:107], v[60:67], v108
  v_exp_f32 v39, v39
  v_exp_f32 v40, v40
  v_exp_f32 v41, v41
  v_exp_f32 v42, v42
  v_mfma_f32_32x32x16_bf16 v[52:67], v[88:91], v[16:19], v[20:35]
  ds_read_b128 v[84:87], v3 offset:24576
  s_mov_b64 exec, s[38:39]
  ds_read_b128 v[100:103], v4 offset:22528
  ds_read_b128 v[104:107], v4 offset:23040
  s_mov_b64 exec, -1
  v_exp_f32 v43, v43
  v_exp_f32 v44, v44
  v_exp_f32 v45, v45
  v_exp_f32 v46, v46
  v_exp_f32 v47, v47
  v_smfmac_f32_32x32x32_bf16 v[68:83], v[92:95], v[36:43], v108
  v_exp_f32 v48, v48
  v_exp_f32 v49, v49
  v_exp_f32 v50, v50
  v_exp_f32 v51, v51
  s_waitcnt lgkmcnt(0)
  global_load_dwordx4 v[204:207], v111, s[6:7]
  s_lshl_b32 s21, s42, 8
  v_lshl_add_u32 v5, v8, 4, s21
  global_load_dwordx4 v[248:251], v5, s[52:53]
  global_load_dwordx4 v[252:255], v9, s[52:53]
  v_exp_f32 v52, v52
  v_exp_f32 v53, v53
  v_exp_f32 v54, v54
  v_smfmac_f32_32x32x32_bf16 v[68:83], v[96:99], v[44:51], v108
  v_exp_f32 v55, v55
  v_exp_f32 v56, v56
  v_exp_f32 v57, v57
  v_exp_f32 v58, v58
  v_mfma_f32_32x32x16_bf16 v[36:51], v[84:87], v[16:19], v[20:35]
  ds_read_b128 v[88:91], v3 offset:26624
  s_mov_b64 exec, s[38:39]
  ds_read_b128 v[92:95], v4 offset:24576
  ds_read_b128 v[96:99], v4 offset:25088
  s_mov_b64 exec, -1
  v_exp_f32 v59, v59
  v_exp_f32 v60, v60
  v_exp_f32 v61, v61
  v_exp_f32 v62, v62
  v_exp_f32 v63, v63
  v_smfmac_f32_32x32x32_bf16 v[68:83], v[100:103], v[52:59], v108
  v_exp_f32 v64, v64
  v_exp_f32 v65, v65
  v_exp_f32 v66, v66
  v_exp_f32 v67, v67
  s_waitcnt lgkmcnt(0)
  s_waitcnt vmcnt(5)
  s_sub_u32 s20, s2, 112
  s_cmp_lt_u32 s20, 32
  s_cbranch_scc1 Lww_50
  s_waitcnt vmcnt(5)
  s_cmp_lt_u32 s2, 112
  s_cbranch_scc1 Lww_50
  s_waitcnt vmcnt(3)
Lww_50:
  ds_read_b64_tr_b16 v[144:145], v110 offset:0
  ds_read_b64_tr_b16 v[146:147], v110 offset:256
  ds_read_b64_tr_b16 v[148:149], v110 offset:1024
  ds_read_b64_tr_b16 v[150:151], v110 offset:1280
  ds_read_b64_tr_b16 v[152:153], v110 offset:2048
  ds_read_b64_tr_b16 v[154:155], v110 offset:2304
  ds_read_b64_tr_b16 v[156:157], v110 offset:3072
  ds_read_b64_tr_b16 v[158:159], v110 offset:3328
  v_exp_f32 v36, v36
  v_exp_f32 v37, v37
  v_exp_f32 v38, v38
  v_smfmac_f32_32x32x32_bf16 v[68:83], v[104:107], v[60:67], v108
  v_exp_f32 v39, v39
  v_exp_f32 v40, v40
  v_exp_f32 v41, v41
  v_exp_f32 v42, v42
  v_mfma_f32_32x32x16_bf16 v[52:67], v[88:91], v[16:19], v[20:35]
  ds_read_b128 v[84:87], v3 offset:28672
  s_mov_b64 exec, s[38:39]
  ds_read_b128 v[100:103], v4 offset:26624
  ds_read_b128 v[104:107], v4 offset:27136
  s_mov_b64 exec, -1
  v_exp_f32 v43, v43
  v_exp_f32 v44, v44
  v_exp_f32 v45, v45
  v_exp_f32 v46, v46
  v_exp_f32 v47, v47
  v_smfmac_f32_32x32x32_bf16 v[68:83], v[92:95], v[36:43], v108
  v_exp_f32 v48, v48
  v_exp_f32 v49, v49
  v_exp_f32 v50, v50
  v_exp_f32 v51, v51
  s_waitcnt lgkmcnt(0)
  s_mov_b32 m0, s36
  s_mov_b32 s20, 393216
  buffer_load_dwordx4 v1, s[12:15], s20 offen offset:0 lds
  s_mov_b32 s20, 424960
  buffer_load_dwordx4 v1, s[12:15], s20 offen offset:1024 lds
  s_mov_b32 s20, 456704
  buffer_load_dwordx4 v1, s[12:15], s20 offen offset:2048 lds
  s_mov_b32 s20, 488448
  buffer_load_dwordx4 v1, s[12:15], s20 offen offset:3072 lds
  v_exp_f32 v52, v52
  v_exp_f32 v53, v53
  v_exp_f32 v54, v54
  v_smfmac_f32_32x32x32_bf16 v[68:83], v[96:99], v[44:51], v108
  v_exp_f32 v55, v55
  v_exp_f32 v56, v56
  v_exp_f32 v57, v57
  v_exp_f32 v58, v58
  v_mfma_f32_32x32x16_bf16 v[36:51], v[84:87], v[16:19], v[20:35]
  ds_read_b128 v[88:91], v3 offset:30720
  s_mov_b64 exec, s[38:39]
  ds_read_b128 v[92:95], v4 offset:28672
  ds_read_b128 v[96:99], v4 offset:29184
  s_mov_b64 exec, -1
  v_exp_f32 v59, v59
  v_exp_f32 v60, v60
  v_exp_f32 v61, v61
  v_exp_f32 v62, v62
  v_exp_f32 v63, v63
  v_smfmac_f32_32x32x32_bf16 v[68:83], v[100:103], v[52:59], v108
  v_exp_f32 v64, v64
  v_exp_f32 v65, v65
  v_exp_f32 v66, v66
  v_exp_f32 v67, v67
  s_waitcnt lgkmcnt(0)
  v_exp_f32 v36, v36
  v_exp_f32 v37, v37
  v_exp_f32 v38, v38
  v_smfmac_f32_32x32x32_bf16 v[68:83], v[104:107], v[60:67], v108
  v_exp_f32 v39, v39
  v_exp_f32 v40, v40
  v_exp_f32 v41, v41
  v_exp_f32 v42, v42
  v_mfma_f32_32x32x16_bf16 v[52:67], v[88:91], v[16:19], v[20:35]
  ds_read_b128 v[84:87], v3 offset:32768
  s_mov_b64 exec, s[38:39]
  ds_read_b128 v[100:103], v4 offset:30720
  ds_read_b128 v[104:107], v4 offset:31232
  s_mov_b64 exec, -1
  v_exp_f32 v43, v43
  v_exp_f32 v44, v44
  v_exp_f32 v45, v45
  v_exp_f32 v46, v46
  v_exp_f32 v47, v47
  v_smfmac_f32_32x32x32_bf16 v[68:83], v[92:95], v[36:43], v108
  v_exp_f32 v48, v48
  v_exp_f32 v49, v49
  v_exp_f32 v50, v50
  v_exp_f32 v51, v51
  s_waitcnt lgkmcnt(0)
  s_cmp_ge_u32 s2, 144
  s_cbranch_scc1 Lmd_51
  s_cmp_lt_u32 s2, 112
  s_cbranch_scc1 Lmd_51
  buffer_load_dwordx4 v[192:195], v109, s[24:27], s43 offen
  s_add_u32 s43, s43, s61
Lmd_51:
  v_exp_f32 v52, v52
  v_exp_f32 v53, v53
  v_exp_f32 v54, v54
  v_smfmac_f32_32x32x32_bf16 v[68:83], v[96:99], v[44:51], v108
  v_exp_f32 v55, v55
  v_exp_f32 v56, v56
  v_exp_f32 v57, v57
  v_exp_f32 v58, v58
  v_mfma_f32_32x32x16_bf16 v[36:51], v[84:87], v[16:19], v[20:35]
  ds_read_b128 v[88:91], v3 offset:34816
  s_mov_b64 exec, s[38:39]
  ds_read_b128 v[92:95], v4 offset:32768
  ds_read_b128 v[96:99], v4 offset:33280
  s_mov_b64 exec, -1
  v_exp_f32 v59, v59
  v_exp_f32 v60, v60
  v_exp_f32 v61, v61
  v_exp_f32 v62, v62
  v_exp_f32 v63, v63
  v_smfmac_f32_32x32x32_bf16 v[68:83], v[100:103], v[52:59], v108
  v_exp_f32 v64, v64
  v_exp_f32 v65, v65
  v_exp_f32 v66, v66
  v_exp_f32 v67, v67
  v_add_u32 v3, 0x8000, v3
  v_add_u32 v4, 0x8000, v4
  s_waitcnt lgkmcnt(0)
  v_exp_f32 v36, v36
  v_exp_f32 v37, v37
  v_exp_f32 v38, v38
  v_smfmac_f32_32x32x32_bf16 v[68:83], v[104:107], v[60:67], v108
  v_exp_f32 v39, v39
  v_exp_f32 v40, v40
  v_exp_f32 v41, v41
  v_exp_f32 v42, v42
  v_mfma_f32_32x32x16_bf16 v[52:67], v[88:91], v[16:19], v[20:35]
  ds_read_b128 v[84:87], v3 offset:4096
  s_mov_b64 exec, s[38:39]
  ds_read_b128 v[100:103], v4 offset:2048
  ds_read_b128 v[104:107], v4 offset:2560
  s_mov_b64 exec, -1
  v_exp_f32 v43, v43
  v_exp_f32 v44, v44
  v_exp_f32 v45, v45
  v_exp_f32 v46, v46
  v_exp_f32 v47, v47
  v_smfmac_f32_32x32x32_bf16 v[68:83], v[92:95], v[36:43], v108
  v_exp_f32 v48, v48
  v_exp_f32 v49, v49
  v_exp_f32 v50, v50
  v_exp_f32 v51, v51
  s_waitcnt lgkmcnt(0)
  s_cmp_ge_u32 s2, 144
  s_cbranch_scc1 Lmd_52
  s_cmp_lt_u32 s2, 112
  s_cbranch_scc1 Lmd_52
  buffer_load_dwordx4 v[196:199], v109, s[24:27], s43 offen
  s_add_u32 s43, s43, s61
Lmd_52:
  v_exp_f32 v52, v52
  v_exp_f32 v53, v53
  v_exp_f32 v54, v54
  v_smfmac_f32_32x32x32_bf16 v[68:83], v[96:99], v[44:51], v108
  v_exp_f32 v55, v55
  v_exp_f32 v56, v56
  v_exp_f32 v57, v57
  v_exp_f32 v58, v58
  v_mfma_f32_32x32x16_bf16 v[36:51], v[84:87], v[16:19], v[20:35]
  ds_read_b128 v[88:91], v3 offset:6144
  s_mov_b64 exec, s[38:39]
  ds_read_b128 v[92:95], v4 offset:4096
  ds_read_b128 v[96:99], v4 offset:4608
  s_mov_b64 exec, -1
  v_exp_f32 v59, v59
  v_exp_f32 v60, v60
  v_exp_f32 v61, v61
  v_exp_f32 v62, v62
  v_exp_f32 v63, v63
  v_smfmac_f32_32x32x32_bf16 v[68:83], v[100:103], v[52:59], v108
  v_exp_f32 v64, v64
  v_exp_f32 v65, v65
  v_exp_f32 v66, v66
  v_exp_f32 v67, v67
  s_waitcnt lgkmcnt(0)
  v_lshlrev_b32 v5, 5, v0
  s_mov_b32 s22, 131072
  buffer_load_dwordx4 v[208:211], v5, s[16:19], s22 offen sc1
  buffer_load_dwordx4 v[212:215], v5, s[16:19], s22 offen offset:16 sc1
  v_exp_f32 v36, v36
  v_exp_f32 v37, v37
  v_exp_f32 v38, v38
  v_smfmac_f32_32x32x32_bf16 v[68:83], v[104:107], v[60:67], v108
  v_exp_f32 v39, v39
  v_exp_f32 v40, v40
  v_exp_f32 v41, v41
  v_exp_f32 v42, v42
  v_mfma_f32_32x32x16_bf16 v[52:67], v[88:91], v[16:19], v[20:35]
  ds_read_b128 v[84:87], v3 offset:8192
  s_mov_b64 exec, s[38:39]
  ds_read_b128 v[100:103], v4 offset:6144
  ds_read_b128 v[104:107], v4 offset:6656
  s_mov_b64 exec, -1
  v_exp_f32 v43, v43
  v_exp_f32 v44, v44
  v_exp_f32 v45, v45
  v_exp_f32 v46, v46
  v_exp_f32 v47, v47
  v_smfmac_f32_32x32x32_bf16 v[68:83], v[92:95], v[36:43], v108
  v_exp_f32 v48, v48
  v_exp_f32 v49, v49
  v_exp_f32 v50, v50
  v_exp_f32 v51, v51
  s_waitcnt lgkmcnt(0)
  s_cmp_ge_u32 s2, 144
  s_cbranch_scc1 Lmd_53
  s_cmp_lt_u32 s2, 112
  s_cbranch_scc1 Lmd_53
  buffer_load_dwordx4 v[200:203], v109, s[24:27], s43 offen
  s_add_u32 s43, s43, s61
Lmd_53:
  v_lshlrev_b32 v5, 5, v0
  s_mov_b32 s22, 147456
  buffer_load_dwordx4 v[216:219], v5, s[16:19], s22 offen sc1
  buffer_load_dwordx4 v[220:223], v5, s[16:19], s22 offen offset:16 sc1
  v_exp_f32 v52, v52
  v_exp_f32 v53, v53
  v_exp_f32 v54, v54
  v_smfmac_f32_32x32x32_bf16 v[68:83], v[96:99], v[44:51], v108
  v_exp_f32 v55, v55
  v_exp_f32 v56, v56
  v_exp_f32 v57, v57
  v_exp_f32 v58, v58
  v_mfma_f32_32x32x16_bf16 v[36:51], v[84:87], v[16:19], v[20:35]
  ds_read_b128 v[88:91], v3 offset:10240
  s_mov_b64 exec, s[38:39]
  ds_read_b128 v[92:95], v4 offset:8192
  ds_read_b128 v[96:99], v4 offset:8704
  s_mov_b64 exec, -1
  v_exp_f32 v59, v59
  v_exp_f32 v60, v60
  v_exp_f32 v61, v61
  v_exp_f32 v62, v62
  v_exp_f32 v63, v63
  v_smfmac_f32_32x32x32_bf16 v[68:83], v[100:103], v[52:59], v108
  v_exp_f32 v64, v64
  v_exp_f32 v65, v65
  v_exp_f32 v66, v66
  v_exp_f32 v67, v67
  s_waitcnt lgkmcnt(0)
  v_lshlrev_b32 v5, 5, v0
  s_mov_b32 s22, 163840
  buffer_load_dwordx4 v[224:227], v5, s[16:19], s22 offen sc1
  buffer_load_dwordx4 v[228:231], v5, s[16:19], s22 offen offset:16 sc1
  v_exp_f32 v36, v36
  v_exp_f32 v37, v37
  v_exp_f32 v38, v38
  v_smfmac_f32_32x32x32_bf16 v[68:83], v[104:107], v[60:67], v108
  v_exp_f32 v39, v39
  v_exp_f32 v40, v40
  v_exp_f32 v41, v41
  v_exp_f32 v42, v42
  v_mfma_f32_32x32x16_bf16 v[52:67], v[88:91], v[16:19], v[20:35]
  ds_read_b128 v[84:87], v3 offset:12288
  s_mov_b64 exec, s[38:39]
  ds_read_b128 v[100:103], v4 offset:10240
  ds_read_b128 v[104:107], v4 offset:10752
  s_mov_b64 exec, -1
  v_exp_f32 v43, v43
  v_exp_f32 v44, v44
  v_exp_f32 v45, v45
  v_exp_f32 v46, v46
  v_exp_f32 v47, v47
  v_smfmac_f32_32x32x32_bf16 v[68:83], v[92:95], v[36:43], v108
  v_exp_f32 v48, v48
  v_exp_f32 v49, v49
  v_exp_f32 v50, v50
  v_exp_f32 v51, v51
  s_waitcnt lgkmcnt(0)
  v_lshlrev_b32 v5, 5, v0
  s_mov_b32 s22, 180224
  buffer_load_dwordx4 v[232:235], v5, s[16:19], s22 offen sc1
  buffer_load_dwordx4 v[236:239], v5, s[16:19], s22 offen offset:16 sc1
  v_exp_f32 v52, v52
  v_exp_f32 v53, v53
  v_exp_f32 v54, v54
  v_smfmac_f32_32x32x32_bf16 v[68:83], v[96:99], v[44:51], v108
  v_exp_f32 v55, v55
  v_exp_f32 v56, v56
  v_exp_f32 v57, v57
  v_exp_f32 v58, v58
  v_mfma_f32_32x32x16_bf16 v[36:51], v[84:87], v[16:19], v[20:35]
  ds_read_b128 v[88:91], v3 offset:14336
  s_mov_b64 exec, s[38:39]
  ds_read_b128 v[92:95], v4 offset:12288
  ds_read_b128 v[96:99], v4 offset:12800
  s_mov_b64 exec, -1
  v_exp_f32 v59, v59
  v_exp_f32 v60, v60
  v_exp_f32 v61, v61
  v_exp_f32 v62, v62
  v_exp_f32 v63, v63
  v_smfmac_f32_32x32x32_bf16 v[68:83], v[100:103], v[52:59], v108
  v_exp_f32 v64, v64
  v_exp_f32 v65, v65
  v_exp_f32 v66, v66
  v_exp_f32 v67, v67
  s_waitcnt lgkmcnt(0)
  s_setprio 0
  s_waitcnt vmcnt(11)
  s_sub_u32 s20, s2, 112
  s_cmp_lt_u32 s20, 32
  s_cbranch_scc1 Lww_55
  s_waitcnt vmcnt(8)
Lww_55:
  ds_read_b64_tr_b16 v[160:161], v110 offset:0
  ds_read_b64_tr_b16 v[162:163], v110 offset:256
  ds_read_b64_tr_b16 v[164:165], v110 offset:1024
  ds_read_b64_tr_b16 v[166:167], v110 offset:1280
  ds_read_b64_tr_b16 v[168:169], v110 offset:2048
  ds_read_b64_tr_b16 v[170:171], v110 offset:2304
  ds_read_b64_tr_b16 v[172:173], v110 offset:3072
  ds_read_b64_tr_b16 v[174:175], v110 offset:3328
  v_exp_f32 v36, v36
  v_exp_f32 v37, v37
  v_exp_f32 v38, v38
  v_smfmac_f32_32x32x32_bf16 v[68:83], v[104:107], v[60:67], v108
  v_exp_f32 v39, v39
  v_exp_f32 v40, v40
  v_exp_f32 v41, v41
  v_exp_f32 v42, v42
  v_mfma_f32_32x32x16_bf16 v[52:67], v[88:91], v[16:19], v[20:35]
  ds_read_b128 v[84:87], v3 offset:16384
  s_mov_b64 exec, s[38:39]
  ds_read_b128 v[100:103], v4 offset:14336
  ds_read_b128 v[104:107], v4 offset:14848
  s_mov_b64 exec, -1
  v_exp_f32 v43, v43
  v_exp_f32 v44, v44
  v_exp_f32 v45, v45
  v_exp_f32 v46, v46
  v_exp_f32 v47, v47
  v_smfmac_f32_32x32x32_bf16 v[68:83], v[92:95], v[36:43], v108
  v_exp_f32 v48, v48
  v_exp_f32 v49, v49
  v_exp_f32 v50, v50
  v_exp_f32 v51, v51
  s_waitcnt lgkmcnt(0)
  v_exp_f32 v52, v52
  v_exp_f32 v53, v53
  v_exp_f32 v54, v54
  v_smfmac_f32_32x32x32_bf16 v[68:83], v[96:99], v[44:51], v108
  v_exp_f32 v55, v55
  v_exp_f32 v56, v56
  v_exp_f32 v57, v57
  v_exp_f32 v58, v58
  v_mfma_f32_32x32x16_bf16 v[36:51], v[84:87], v[16:19], v[20:35]
  ds_read_b128 v[88:91], v3 offset:18432
  s_mov_b64 exec, s[38:39]
  ds_read_b128 v[92:95], v4 offset:16384
  ds_read_b128 v[96:99], v4 offset:16896
  s_mov_b64 exec, -1
  v_exp_f32 v59, v59
  v_exp_f32 v60, v60
  v_exp_f32 v61, v61
  v_exp_f32 v62, v62
  v_exp_f32 v63, v63
  v_smfmac_f32_32x32x32_bf16 v[68:83], v[100:103], v[52:59], v108
  v_exp_f32 v64, v64
  v_exp_f32 v65, v65
  v_exp_f32 v66, v66
  v_exp_f32 v67, v67
  s_waitcnt lgkmcnt(0)
  v_add_u32 v1, s36, v9
  v_exp_f32 v36, v36
  v_exp_f32 v37, v37
  v_exp_f32 v38, v38
  v_smfmac_f32_32x32x32_bf16 v[68:83], v[104:107], v[60:67], v108
  v_exp_f32 v39, v39
  v_exp_f32 v40, v40
  v_exp_f32 v41, v41
  v_exp_f32 v42, v42
  v_mfma_f32_32x32x16_bf16 v[52:67], v[88:91], v[16:19], v[20:35]
  ds_read_b128 v[84:87], v3 offset:20480
  s_mov_b64 exec, s[38:39]
  ds_read_b128 v[100:103], v4 offset:18432
  ds_read_b128 v[104:107], v4 offset:18944
  s_mov_b64 exec, -1
  v_exp_f32 v43, v43
  v_exp_f32 v44, v44
  v_exp_f32 v45, v45
  v_exp_f32 v46, v46
  v_exp_f32 v47, v47
  v_smfmac_f32_32x32x32_bf16 v[68:83], v[92:95], v[36:43], v108
  v_exp_f32 v48, v48
  v_exp_f32 v49, v49
  v_exp_f32 v50, v50
  v_exp_f32 v51, v51
  s_waitcnt lgkmcnt(0)
  v_exp_f32 v52, v52
  v_exp_f32 v53, v53
  v_exp_f32 v54, v54
  v_smfmac_f32_32x32x32_bf16 v[68:83], v[96:99], v[44:51], v108
  v_exp_f32 v55, v55
  v_exp_f32 v56, v56
  v_exp_f32 v57, v57
  v_exp_f32 v58, v58
  v_mfma_f32_32x32x16_bf16 v[36:51], v[84:87], v[16:19], v[20:35]
  ds_read_b128 v[88:91], v3 offset:22528
  s_mov_b64 exec, s[38:39]
  ds_read_b128 v[92:95], v4 offset:20480
  ds_read_b128 v[96:99], v4 offset:20992
  s_mov_b64 exec, -1
  v_exp_f32 v59, v59
  v_exp_f32 v60, v60
  v_exp_f32 v61, v61
  v_exp_f32 v62, v62
  v_exp_f32 v63, v63
  v_smfmac_f32_32x32x32_bf16 v[68:83], v[100:103], v[52:59], v108
  v_exp_f32 v64, v64
  v_exp_f32 v65, v65
  v_exp_f32 v66, v66
  v_exp_f32 v67, v67
  s_waitcnt lgkmcnt(0)
  v_exp_f32 v36, v36
  v_exp_f32 v37, v37
  v_exp_f32 v38, v38
  v_smfmac_f32_32x32x32_bf16 v[68:83], v[104:107], v[60:67], v108
  v_exp_f32 v39, v39
  v_exp_f32 v40, v40
  v_exp_f32 v41, v41
  v_exp_f32 v42, v42
  v_mfma_f32_32x32x16_bf16 v[52:67], v[88:91], v[16:19], v[20:35]
  ds_read_b128 v[84:87], v3 offset:24576
  s_mov_b64 exec, s[38:39]
  ds_read_b128 v[100:103], v4 offset:22528
  ds_read_b128 v[104:107], v4 offset:23040
  s_mov_b64 exec, -1
  v_exp_f32 v43, v43
  v_exp_f32 v44, v44
  v_exp_f32 v45, v45
  v_exp_f32 v46, v46
  v_exp_f32 v47, v47
  v_smfmac_f32_32x32x32_bf16 v[68:83], v[92:95], v[36:43], v108
  v_exp_f32 v48, v48
  v_exp_f32 v49, v49
  v_exp_f32 v50, v50
  v_exp_f32 v51, v51
  s_waitcnt lgkmcnt(0)
  v_exp_f32 v52, v52
  v_exp_f32 v53, v53
  v_exp_f32 v54, v54
  v_smfmac_f32_32x32x32_bf16 v[68:83], v[96:99], v[44:51], v108
  v_exp_f32 v55, v55
  v_exp_f32 v56, v56
  v_exp_f32 v57, v57
  v_exp_f32 v58, v58
  v_mfma_f32_32x32x16_bf16 v[36:51], v[84:87], v[16:19], v[20:35]
  ds_read_b128 v[88:91], v3 offset:26624
  s_mov_b64 exec, s[38:39]
  ds_read_b128 v[92:95], v4 offset:24576
  ds_read_b128 v[96:99], v4 offset:25088
  s_mov_b64 exec, -1
  v_exp_f32 v59, v59
  v_exp_f32 v60, v60
  v_exp_f32 v61, v61
  v_exp_f32 v62, v62
  v_exp_f32 v63, v63
  v_smfmac_f32_32x32x32_bf16 v[68:83], v[100:103], v[52:59], v108
  v_exp_f32 v64, v64
  v_exp_f32 v65, v65
  v_exp_f32 v66, v66
  v_exp_f32 v67, v67
  s_waitcnt lgkmcnt(0)
  v_exp_f32 v36, v36
  v_exp_f32 v37, v37
  v_exp_f32 v38, v38
  v_smfmac_f32_32x32x32_bf16 v[68:83], v[104:107], v[60:67], v108
  v_exp_f32 v39, v39
  v_exp_f32 v40, v40
  v_exp_f32 v41, v41
  v_exp_f32 v42, v42
  v_mfma_f32_32x32x16_bf16 v[52:67], v[88:91], v[16:19], v[20:35]
  ds_read_b128 v[84:87], v3 offset:28672
  s_mov_b64 exec, s[38:39]
  ds_read_b128 v[100:103], v4 offset:26624
  ds_read_b128 v[104:107], v4 offset:27136
  s_mov_b64 exec, -1
  v_exp_f32 v43, v43
  v_exp_f32 v44, v44
  v_exp_f32 v45, v45
  v_exp_f32 v46, v46
  v_exp_f32 v47, v47
  v_smfmac_f32_32x32x32_bf16 v[68:83], v[92:95], v[36:43], v108
  v_exp_f32 v48, v48
  v_exp_f32 v49, v49
  v_exp_f32 v50, v50
  v_exp_f32 v51, v51
  s_waitcnt lgkmcnt(0)
  v_exp_f32 v52, v52
  v_exp_f32 v53, v53
  v_exp_f32 v54, v54
  v_smfmac_f32_32x32x32_bf16 v[68:83], v[96:99], v[44:51], v108
  v_exp_f32 v55, v55
  v_exp_f32 v56, v56
  v_exp_f32 v57, v57
  v_exp_f32 v58, v58
  v_mfma_f32_32x32x16_bf16 v[36:51], v[84:87], v[16:19], v[20:35]
  ds_read_b128 v[88:91], v3 offset:30720
  s_mov_b64 exec, s[38:39]
  ds_read_b128 v[92:95], v4 offset:28672
  ds_read_b128 v[96:99], v4 offset:29184
  s_mov_b64 exec, -1
  v_exp_f32 v59, v59
  v_exp_f32 v60, v60
  v_exp_f32 v61, v61
  v_exp_f32 v62, v62
  v_exp_f32 v63, v63
  v_smfmac_f32_32x32x32_bf16 v[68:83], v[100:103], v[52:59], v108
  v_exp_f32 v64, v64
  v_exp_f32 v65, v65
  v_exp_f32 v66, v66
  v_exp_f32 v67, v67
  s_waitcnt lgkmcnt(0)
  v_exp_f32 v36, v36
  v_exp_f32 v37, v37
  v_exp_f32 v38, v38
  v_smfmac_f32_32x32x32_bf16 v[68:83], v[104:107], v[60:67], v108
  v_exp_f32 v39, v39
  v_exp_f32 v40, v40
  v_exp_f32 v41, v41
  v_exp_f32 v42, v42
  v_mfma_f32_32x32x16_bf16 v[52:67], v[88:91], v[16:19], v[20:35]
  ds_read_b128 v[84:87], v3 offset:32768
  s_mov_b64 exec, s[38:39]
  ds_read_b128 v[100:103], v4 offset:30720
  ds_read_b128 v[104:107], v4 offset:31232
  s_mov_b64 exec, -1
  v_exp_f32 v43, v43
  v_exp_f32 v44, v44
  v_exp_f32 v45, v45
  v_exp_f32 v46, v46
  v_exp_f32 v47, v47
  v_smfmac_f32_32x32x32_bf16 v[68:83], v[92:95], v[36:43], v108
  v_exp_f32 v48, v48
  v_exp_f32 v49, v49
  v_exp_f32 v50, v50
  v_exp_f32 v51, v51
  s_waitcnt lgkmcnt(0)
  v_exp_f32 v52, v52
  v_exp_f32 v53, v53
  v_exp_f32 v54, v54
  v_smfmac_f32_32x32x32_bf16 v[68:83], v[96:99], v[44:51], v108
  v_exp_f32 v55, v55
  v_exp_f32 v56, v56
  v_exp_f32 v57, v57
  v_exp_f32 v58, v58
  v_mfma_f32_32x32x16_bf16 v[36:51], v[84:87], v[16:19], v[20:35]
  ds_read_b128 v[88:91], v3 offset:34816
  s_mov_b64 exec, s[38:39]
  ds_read_b128 v[92:95], v4 offset:32768
  ds_read_b128 v[96:99], v4 offset:33280
  s_mov_b64 exec, -1
  v_exp_f32 v59, v59
  v_exp_f32 v60, v60
  v_exp_f32 v61, v61
  v_exp_f32 v62, v62
  v_exp_f32 v63, v63
  v_smfmac_f32_32x32x32_bf16 v[68:83], v[100:103], v[52:59], v108
  v_exp_f32 v64, v64
  v_exp_f32 v65, v65
  v_exp_f32 v66, v66
  v_exp_f32 v67, v67
  v_subrev_u32 v3, 0x18000, v3
  v_subrev_u32 v4, 0x18000, v4
main_attn_tail:
  v_smfmac_f32_32x32x32_bf16 v[68:83], v[104:107], v[60:67], v108
  s_lshl_b32 s21, s34, 15
  s_lshl_b32 s22, s30, 10
  s_add_u32 s21, s21, s22
  s_add_u32 s21, s21, 9437184
  v_mov_b32 v6, 0x53800000
  s_waitcnt lgkmcnt(0)
  s_nop 5
  v_mov_b32 v7, v76
  v_add_f32 v5, abs(v68), abs(v69)
  v_add_f32 v5, v5, abs(v70)
  v_permlane32_swap_b32 v76, v7
  v_add_f32 v5, v5, abs(v71)
  v_add_f32 v5, v5, abs(v72)
  v_add_f32 v5, v5, abs(v73)
  v_add_f32 v5, v5, abs(v74)
  v_add_f32 v5, v5, abs(v75)
  v_mov_b32 v7, 0x7f61b1e6
  v_cmp_nle_f32 vcc, v76, v6
  v_cmp_nle_f32 s[22:23], v5, v7
  s_or_b64 vcc, vcc, s[22:23]
  s_cmp_lg_u32 s37, 0
  s_cbranch_scc1 main_fin
  s_cbranch_vccnz main_fallback
main_fin:
  v_rcp_f32 v6, v76
  s_nop 0
  v_mul_f32 v68, v68, v6
  v_mul_f32 v69, v69, v6
  v_mul_f32 v70, v70, v6
  v_mul_f32 v71, v71, v6
  v_mul_f32 v72, v72, v6
  v_mul_f32 v73, v73, v6
  v_mul_f32 v74, v74, v6
  v_mul_f32 v75, v75, v6
  v_cvt_pk_bf16_f32 v16, v68, v69
  v_cvt_pk_bf16_f32 v17, v70, v71
  v_cvt_pk_bf16_f32 v18, v72, v73
  v_cvt_pk_bf16_f32 v19, v74, v75
  buffer_store_dwordx4 v[16:19], v9, s[16:19], s21 offen sc1
  s_lshl_b32 s21, s34, 12
  s_lshl_b32 s22, s30, 7
  s_add_u32 s21, s21, s22
  s_add_u32 s21, s21, 1310720
  v_mov_b32 v5, 0
  v_mov_b32 v6, s48
  v_lshrrev_b32 v20, 5, v2
  v_lshlrev_b32 v20, 10, v20
  v_bfe_u32 v21, v2, 4, 1
  v_lshl_add_u32 v20, v21, 9, v20
  v_lshl_add_u32 v20, v8, 4, v20
  v_mul_u32_u24 v22, 528, v8
  v_lshrrev_b32 v23, 4, v2
  v_lshl_add_u32 v22, v23, 4, v22
  s_lshl_b32 s22, s32, 6
  s_add_u32 s22, s22, 32768
  v_add_u32 v22, s22, v22
  v_lshrrev_b32 v24, 4, v0
  v_mul_u32_u24 v23, 528, v24
  v_lshl_add_u32 v23, v8, 5, v23
  v_add_u32 v23, 32768, v23
  v_and_b32 v12, 48, v2
  s_lshl_b32 s22, s32, 7
  v_add_u32 v12, s22, v12
  v_and_b32 v13, 3, v0
  v_lshl_add_u32 v13, v13, 10, v12
  v_lshrrev_b32 v109, 10, v111
  v_sub_u32 v109, 2047, v109
  v_lshl_or_b32 v109, v109, 1, 1
  v_lshlrev_b32 v110, 2, v24
  v_add_u32 v110, 65536, v110
  s_waitcnt vmcnt(0)
  v_lshlrev_b32 v40, 16, v204
  v_and_b32 v41, 0xffff0000, v204
  v_lshlrev_b32 v42, 16, v205
  v_and_b32 v43, 0xffff0000, v205
  v_lshlrev_b32 v44, 16, v206
  v_and_b32 v45, 0xffff0000, v206
  v_lshlrev_b32 v46, 16, v207
  v_and_b32 v47, 0xffff0000, v207
  s_mov_b64 exec, 1
  buffer_store_dword v6, v5, s[16:19], s21 offen sc1
  s_mov_b64 exec, -1
  ds_write_b128 v1, v[176:179] offset:0
  ds_write_b128 v1, v[180:183] offset:1024
  ds_write_b128 v1, v[184:187] offset:2048
  ds_write_b128 v1, v[188:191] offset:3072
  ds_read_b64_tr_b16 v[176:177], v14 offset:0
  ds_read_b64_tr_b16 v[178:179], v15 offset:0
  ds_read_b64_tr_b16 v[180:181], v14 offset:1024
  ds_read_b64_tr_b16 v[182:183], v15 offset:1024
  ds_read_b64_tr_b16 v[184:185], v14 offset:2048
  ds_read_b64_tr_b16 v[186:187], v15 offset:2048
  ds_read_b64_tr_b16 v[188:189], v14 offset:3072
  ds_read_b64_tr_b16 v[190:191], v15 offset:3072
  ds_write_b128 v1, v[192:195] offset:0
  ds_write_b128 v1, v[196:199] offset:1024
  ds_write_b128 v1, v[200:203] offset:2048
  ds_read_b64_tr_b16 v[192:193], v14 offset:0
  ds_read_b64_tr_b16 v[194:195], v15 offset:0
  ds_read_b64_tr_b16 v[196:197], v14 offset:1024
  ds_read_b64_tr_b16 v[198:199], v15 offset:1024
  ds_read_b64_tr_b16 v[200:201], v14 offset:2048
  ds_read_b64_tr_b16 v[202:203], v15 offset:2048
  v_cmp_ne_u32 vcc, s48, v209
  v_cmp_ne_u32 s[20:21], s48, v211
  s_or_b64 vcc, vcc, s[20:21]
  v_cmp_ne_u32 s[20:21], s48, v213
  s_or_b64 vcc, vcc, s[20:21]
  v_cmp_ne_u32 s[20:21], s48, v215
  s_or_b64 vcc, vcc, s[20:21]
  v_cmp_ne_u32 s[20:21], s48, v217
  s_or_b64 vcc, vcc, s[20:21]
  v_cmp_ne_u32 s[20:21], s48, v219
  s_or_b64 vcc, vcc, s[20:21]
  v_cmp_ne_u32 s[20:21], s48, v221
  s_or_b64 vcc, vcc, s[20:21]
  v_cmp_ne_u32 s[20:21], s48, v223
  s_or_b64 vcc, vcc, s[20:21]
  v_cmp_ne_u32 s[20:21], s48, v225
  s_or_b64 vcc, vcc, s[20:21]
  v_cmp_ne_u32 s[20:21], s48, v227
  s_or_b64 vcc, vcc, s[20:21]
  v_cmp_ne_u32 s[20:21], s48, v229
  s_or_b64 vcc, vcc, s[20:21]
  v_cmp_ne_u32 s[20:21], s48, v231
  s_or_b64 vcc, vcc, s[20:21]
  v_cmp_ne_u32 s[20:21], s48, v233
  s_or_b64 vcc, vcc, s[20:21]
  v_cmp_ne_u32 s[20:21], s48, v235
  s_or_b64 vcc, vcc, s[20:21]
  v_cmp_ne_u32 s[20:21], s48, v237
  s_or_b64 vcc, vcc, s[20:21]
  v_cmp_ne_u32 s[20:21], s48, v239
  s_or_b64 vcc, vcc, s[20:21]
  s_cmp_eq_u64 vcc, 0
  s_cbranch_scc1 main_lok
  s_mov_b32 s60, 50000
Ll_56:
  v_lshlrev_b32 v5, 5, v0
  s_mov_b32 s22, 131072
  buffer_load_dwordx4 v[208:211], v5, s[16:19], s22 offen sc1
  buffer_load_dwordx4 v[212:215], v5, s[16:19], s22 offen offset:16 sc1
  s_mov_b32 s22, 147456
  buffer_load_dwordx4 v[216:219], v5, s[16:19], s22 offen sc1
  buffer_load_dwordx4 v[220:223], v5, s[16:19], s22 offen offset:16 sc1
  s_mov_b32 s22, 163840
  buffer_load_dwordx4 v[224:227], v5, s[16:19], s22 offen sc1
  buffer_load_dwordx4 v[228:231], v5, s[16:19], s22 offen offset:16 sc1
  s_mov_b32 s22, 180224
  buffer_load_dwordx4 v[232:235], v5, s[16:19], s22 offen sc1
  buffer_load_dwordx4 v[236:239], v5, s[16:19], s22 offen offset:16 sc1
  s_waitcnt vmcnt(0)
  v_cmp_ne_u32 vcc, s48, v209
  v_cmp_ne_u32 s[20:21], s48, v211
  s_or_b64 vcc, vcc, s[20:21]
  v_cmp_ne_u32 s[20:21], s48, v213
  s_or_b64 vcc, vcc, s[20:21]
  v_cmp_ne_u32 s[20:21], s48, v215
  s_or_b64 vcc, vcc, s[20:21]
  v_cmp_ne_u32 s[20:21], s48, v217
  s_or_b64 vcc, vcc, s[20:21]
  v_cmp_ne_u32 s[20:21], s48, v219
  s_or_b64 vcc, vcc, s[20:21]
  v_cmp_ne_u32 s[20:21], s48, v221
  s_or_b64 vcc, vcc, s[20:21]
  v_cmp_ne_u32 s[20:21], s48, v223
  s_or_b64 vcc, vcc, s[20:21]
  v_cmp_ne_u32 s[20:21], s48, v225
  s_or_b64 vcc, vcc, s[20:21]
  v_cmp_ne_u32 s[20:21], s48, v227
  s_or_b64 vcc, vcc, s[20:21]
  v_cmp_ne_u32 s[20:21], s48, v229
  s_or_b64 vcc, vcc, s[20:21]
  v_cmp_ne_u32 s[20:21], s48, v231
  s_or_b64 vcc, vcc, s[20:21]
  v_cmp_ne_u32 s[20:21], s48, v233
  s_or_b64 vcc, vcc, s[20:21]
  v_cmp_ne_u32 s[20:21], s48, v235
  s_or_b64 vcc, vcc, s[20:21]
  v_cmp_ne_u32 s[20:21], s48, v237
  s_or_b64 vcc, vcc, s[20:21]
  v_cmp_ne_u32 s[20:21], s48, v239
  s_or_b64 vcc, vcc, s[20:21]
  s_cmp_eq_u64 vcc, 0
  s_cbranch_scc1 Lld_57
  s_sub_u32 s60, s60, 1
  s_sleep 4
  s_cmp_lg_u32 s60, 0
  s_cbranch_scc1 Ll_56
Lld_57:
main_lok:
  v_add_f32 v208, v208, v216
  v_add_f32 v224, v224, v232
  v_add_f32 v56, v208, v224
  v_add_f32 v210, v210, v218
  v_add_f32 v226, v226, v234
  v_add_f32 v57, v210, v226
  v_add_f32 v212, v212, v220
  v_add_f32 v228, v228, v236
  v_add_f32 v58, v212, v228
  v_add_f32 v214, v214, v222
  v_add_f32 v230, v230, v238
  v_add_f32 v59, v214, v230
  s_lshr_b32 s20, s32, 1
  s_cmp_eq_u32 s20, 2
  s_cselect_b32 s20, 1.0, 0
  v_cvt_pk_bf16_f32 v5, v56, v57
  v_lshlrev_b32 v56, 16, v5
  v_and_b32 v57, 0xffff0000, v5
  v_cvt_pk_bf16_f32 v5, v58, v59
  v_lshlrev_b32 v58, 16, v5
  v_and_b32 v59, 0xffff0000, v5
  v_add_f32 v56, s20, v56
  v_add_f32 v57, s20, v57
  v_add_f32 v58, s20, v58
  v_add_f32 v59, s20, v59
  v_cvt_pk_bf16_f32 v5, v56, v57
  v_lshlrev_b32 v56, 16, v5
  v_and_b32 v57, 0xffff0000, v5
  v_cvt_pk_bf16_f32 v5, v58, v59
  v_lshlrev_b32 v58, 16, v5
  v_and_b32 v59, 0xffff0000, v5
  ds_write_b128 v1, v[56:59]
  s_lshr_b32 s20, s42, 1
  s_lshl_b32 s20, s20, 12
  s_and_b32 s21, s42, 1
  s_lshl_b32 s21, s21, 9
  s_add_u32 s20, s20, s21
  s_add_u32 s20, s20, 131072
  v_lshl_add_u32 v10, v8, 5, s20
  v_lshrrev_b32 v11, 5, v2
  v_lshlrev_b32 v11, 12, v11
  v_and_b32 v5, 31, v2
  v_lshl_add_u32 v11, v5, 5, v11
  v_add_u32 v11, 131072, v11
  v_lshlrev_b32 v72, 16, v252
  v_and_b32 v73, 0xffff0000, v252
  v_lshlrev_b32 v74, 16, v253
  v_and_b32 v75, 0xffff0000, v253
  v_lshlrev_b32 v76, 16, v254
  v_and_b32 v77, 0xffff0000, v254
  v_lshlrev_b32 v78, 16, v255
  v_and_b32 v79, 0xffff0000, v255
  v_lshlrev_b32 v240, 16, v248
  v_and_b32 v241, 0xffff0000, v248
  v_lshlrev_b32 v242, 16, v249
  v_and_b32 v243, 0xffff0000, v249
  v_lshlrev_b32 v244, 16, v250
  v_and_b32 v245, 0xffff0000, v250
  v_lshlrev_b32 v246, 16, v251
  v_and_b32 v247, 0xffff0000, v251
  s_waitcnt lgkmcnt(0)
  s_cmp_lg_u32 s32, 0
  s_cbranch_scc1 main_s2
  v_and_b32 v5, 31, v2
  v_lshlrev_b32 v5, 7, v5
  s_lshl_b32 s22, s41, 12
  s_add_u32 s22, s22, 1310720
  s_mov_b32 s60, 50000
Lo_59:
  buffer_load_dword v6, v5, s[16:19], s22 offen sc1
  s_waitcnt vmcnt(0)
  v_cmp_ne_u32 vcc, s48, v6
  s_cmp_eq_u64 vcc, 0
  s_cbranch_scc1 Lod_60
  s_sub_u32 s60, s60, 1
  s_sleep 1
  s_cmp_lg_u32 s60, 0
  s_cbranch_scc1 Lo_59
Lod_60:
main_s2:
  s_lshl_b32 s23, s32, 12
  s_lshl_b32 s22, s41, 15
  s_add_u32 s22, s22, s23
  s_add_u32 s62, s22, 9437184
  v_add_u32 v27, s23, v9
  s_mov_b32 m0, s23
  s_barrier
  buffer_load_dwordx4 v9, s[16:19], s62 offen offset:0 sc1 lds
  buffer_load_dwordx4 v9, s[16:19], s62 offen offset:1024 sc1 lds
  buffer_load_dwordx4 v9, s[16:19], s62 offen offset:2048 sc1 lds
  buffer_load_dwordx4 v9, s[16:19], s62 offen offset:3072 sc1 lds
  s_lshl_b32 s21, s41, 12
  s_add_u32 s21, s21, 1572864
  s_lshl_b32 s22, s42, 10
  s_add_u32 s22, s22, s21
  s_mov_b32 s24, 0x00010001
  s_mov_b32 s25, 0x00010001
  v_mov_b32 v55, s48
  ds_read_b128 v[208:211], v10 offset:0
  ds_read_b128 v[212:215], v10 offset:16
  ds_read_b128 v[216:219], v10 offset:8192
  ds_read_b128 v[220:223], v10 offset:8208
  ds_read_b128 v[224:227], v10 offset:16384
  ds_read_b128 v[228:231], v10 offset:16400
  ds_read_b128 v[232:235], v10 offset:24576
  ds_read_b128 v[236:239], v10 offset:24592
  ds_read_b128 v[56:59], v11 offset:8192
  ds_read_b128 v[60:63], v11 offset:8208
  ds_read_b128 v[64:67], v11 offset:16384
  ds_read_b128 v[68:71], v11 offset:16400
  s_waitcnt lgkmcnt(0)
  v_mul_f32 v240, v240, v224
  v_mul_f32 v241, v241, v225
  v_mul_f32 v242, v242, v226
  v_mul_f32 v243, v243, v227
  v_mul_f32 v244, v244, v228
  v_mul_f32 v245, v245, v229
  v_mul_f32 v246, v246, v230
  v_mul_f32 v247, v247, v231
  v_mul_f32 v252, v72, v64
  v_mul_f32 v253, v72, v56
  v_fmac_f32 v252, v73, v65
  v_fmac_f32 v253, v73, v57
  v_fmac_f32 v252, v74, v66
  v_fmac_f32 v253, v74, v58
  v_fmac_f32 v252, v75, v67
  v_fmac_f32 v253, v75, v59
  v_fmac_f32 v252, v76, v68
  v_fmac_f32 v253, v76, v60
  v_fmac_f32 v252, v77, v69
  v_fmac_f32 v253, v77, v61
  v_fmac_f32 v252, v78, v70
  v_fmac_f32 v253, v78, v62
  v_fmac_f32 v252, v79, v71
  v_fmac_f32 v253, v79, v63
  s_nop 1
  v_add_f32_dpp v252, v252, v252 row_ror:8 row_mask:0xf bank_mask:0xf
  v_add_f32_dpp v253, v253, v253 row_ror:8 row_mask:0xf bank_mask:0xf
  s_nop 0
  v_add_f32_dpp v252, v252, v252 row_ror:4 row_mask:0xf bank_mask:0xf
  v_add_f32_dpp v253, v253, v253 row_ror:4 row_mask:0xf bank_mask:0xf
  s_nop 0
  v_add_f32_dpp v252, v252, v252 row_ror:2 row_mask:0xf bank_mask:0xf
  v_add_f32_dpp v253, v253, v253 row_ror:2 row_mask:0xf bank_mask:0xf
  s_nop 0
  v_add_f32_dpp v252, v252, v252 row_ror:1 row_mask:0xf bank_mask:0xf
  v_add_f32_dpp v253, v253, v253 row_ror:1 row_mask:0xf bank_mask:0xf
  s_nop 0
  v_mov_b32 v5, v252
  v_mov_b32 v6, v253
  s_nop 1
  v_permlane16_swap_b32 v5, v252
  v_permlane16_swap_b32 v6, v253
  s_nop 1
  v_add_f32 v252, v252, v5
  v_add_f32 v253, v253, v6
  v_mov_b32 v5, v252
  v_mov_b32 v6, v253
  s_nop 1
  v_permlane32_swap_b32 v5, v252
  v_permlane32_swap_b32 v6, v253
  s_nop 1
  v_add_f32 v252, v252, v5
  v_add_f32 v253, v253, v6
  s_waitcnt vmcnt(0)
  s_barrier
  ds_read_b128 v[56:59], v20 offset:0
  ds_read_b128 v[60:63], v20 offset:256
  ds_read_b128 v[64:67], v20 offset:2048
  ds_read_b128 v[68:71], v20 offset:2304
  ds_read_b128 v[72:75], v20 offset:4096
  ds_read_b128 v[76:79], v20 offset:4352
  ds_read_b128 v[80:83], v20 offset:6144
  ds_read_b128 v[84:87], v20 offset:6400
  s_waitcnt lgkmcnt(6)
  v_mfma_f32_16x16x32_bf16 v[24:27], v[112:115], v[56:59], 0
  v_mfma_f32_16x16x32_bf16 v[28:31], v[112:115], v[60:63], 0
  ds_read_b128 v[56:59], v20 offset:8192
  ds_read_b128 v[60:63], v20 offset:8448
  s_waitcnt lgkmcnt(6)
  v_mfma_f32_16x16x32_bf16 v[24:27], v[116:119], v[64:67], v[24:27]
  v_mfma_f32_16x16x32_bf16 v[28:31], v[116:119], v[68:71], v[28:31]
  ds_read_b128 v[64:67], v20 offset:10240
  ds_read_b128 v[68:71], v20 offset:10496
  s_waitcnt lgkmcnt(6)
  v_mfma_f32_16x16x32_bf16 v[24:27], v[120:123], v[72:75], v[24:27]
  v_mfma_f32_16x16x32_bf16 v[28:31], v[120:123], v[76:79], v[28:31]
  ds_read_b128 v[72:75], v20 offset:12288
  ds_read_b128 v[76:79], v20 offset:12544
  s_waitcnt lgkmcnt(6)
  v_mfma_f32_16x16x32_bf16 v[24:27], v[124:127], v[80:83], v[24:27]
  v_mfma_f32_16x16x32_bf16 v[28:31], v[124:127], v[84:87], v[28:31]
  ds_read_b128 v[80:83], v20 offset:14336
  ds_read_b128 v[84:87], v20 offset:14592
  s_waitcnt lgkmcnt(6)
  v_mfma_f32_16x16x32_bf16 v[24:27], v[128:131], v[56:59], v[24:27]
  v_mfma_f32_16x16x32_bf16 v[28:31], v[128:131], v[60:63], v[28:31]
  ds_read_b128 v[56:59], v20 offset:16384
  ds_read_b128 v[60:63], v20 offset:16640
  s_waitcnt lgkmcnt(6)
  v_mfma_f32_16x16x32_bf16 v[24:27], v[132:135], v[64:67], v[24:27]
  v_mfma_f32_16x16x32_bf16 v[28:31], v[132:135], v[68:71], v[28:31]
  ds_read_b128 v[64:67], v20 offset:18432
  ds_read_b128 v[68:71], v20 offset:18688
  s_waitcnt lgkmcnt(6)
  v_mfma_f32_16x16x32_bf16 v[24:27], v[136:139], v[72:75], v[24:27]
  v_mfma_f32_16x16x32_bf16 v[28:31], v[136:139], v[76:79], v[28:31]
  ds_read_b128 v[72:75], v20 offset:20480
  ds_read_b128 v[76:79], v20 offset:20736
  s_waitcnt lgkmcnt(6)
  v_mfma_f32_16x16x32_bf16 v[24:27], v[140:143], v[80:83], v[24:27]
  v_mfma_f32_16x16x32_bf16 v[28:31], v[140:143], v[84:87], v[28:31]
  ds_read_b128 v[80:83], v20 offset:22528
  ds_read_b128 v[84:87], v20 offset:22784
  s_waitcnt lgkmcnt(6)
  v_mfma_f32_16x16x32_bf16 v[24:27], v[144:147], v[56:59], v[24:27]
  v_mfma_f32_16x16x32_bf16 v[28:31], v[144:147], v[60:63], v[28:31]
  ds_read_b128 v[56:59], v20 offset:24576
  ds_read_b128 v[60:63], v20 offset:24832
  s_waitcnt lgkmcnt(6)
  v_mfma_f32_16x16x32_bf16 v[24:27], v[148:151], v[64:67], v[24:27]
  v_mfma_f32_16x16x32_bf16 v[28:31], v[148:151], v[68:71], v[28:31]
  ds_read_b128 v[64:67], v20 offset:26624
  ds_read_b128 v[68:71], v20 offset:26880
  s_waitcnt lgkmcnt(6)
  v_mfma_f32_16x16x32_bf16 v[24:27], v[152:155], v[72:75], v[24:27]
  v_mfma_f32_16x16x32_bf16 v[28:31], v[152:155], v[76:79], v[28:31]
  ds_read_b128 v[72:75], v20 offset:28672
  ds_read_b128 v[76:79], v20 offset:28928
  s_waitcnt lgkmcnt(6)
  v_mfma_f32_16x16x32_bf16 v[24:27], v[156:159], v[80:83], v[24:27]
  v_mfma_f32_16x16x32_bf16 v[28:31], v[156:159], v[84:87], v[28:31]
  ds_read_b128 v[80:83], v20 offset:30720
  ds_read_b128 v[84:87], v20 offset:30976
  s_waitcnt lgkmcnt(6)
  v_mfma_f32_16x16x32_bf16 v[24:27], v[160:163], v[56:59], v[24:27]
  v_mfma_f32_16x16x32_bf16 v[28:31], v[160:163], v[60:63], v[28:31]
  s_waitcnt lgkmcnt(4)
  v_mfma_f32_16x16x32_bf16 v[24:27], v[164:167], v[64:67], v[24:27]
  v_mfma_f32_16x16x32_bf16 v[28:31], v[164:167], v[68:71], v[28:31]
  s_waitcnt lgkmcnt(2)
  v_mfma_f32_16x16x32_bf16 v[24:27], v[168:171], v[72:75], v[24:27]
  v_mfma_f32_16x16x32_bf16 v[28:31], v[168:171], v[76:79], v[28:31]
  s_waitcnt lgkmcnt(0)
  v_mfma_f32_16x16x32_bf16 v[24:27], v[172:175], v[80:83], v[24:27]
  v_mfma_f32_16x16x32_bf16 v[28:31], v[172:175], v[84:87], v[28:31]
  s_nop 6
  ds_write_b128 v22, v[24:27]
  ds_write_b128 v22, v[28:31] offset:8448
  s_waitcnt lgkmcnt(0)
  s_barrier
  ds_read_b128 v[32:35], v23
  ds_read_b128 v[36:39], v23 offset:16
  s_mov_b32 s23, 0xffff0000
  s_waitcnt lgkmcnt(0)
  v_cvt_pk_bf16_f32 v56, v32, v33
  v_cvt_pk_bf16_f32 v57, v34, v35
  v_cvt_pk_bf16_f32 v58, v36, v37
  v_cvt_pk_bf16_f32 v59, v38, v39
  v_lshlrev_b32 v32, 16, v56
  v_and_b32 v33, s23, v56
  v_lshlrev_b32 v34, 16, v57
  v_and_b32 v35, s23, v57
  v_lshlrev_b32 v36, 16, v58
  v_and_b32 v37, s23, v58
  v_lshlrev_b32 v38, 16, v59
  v_and_b32 v39, s23, v59
  v_pk_mul_f32 v[32:33], v[32:33], v[208:209]
  v_pk_mul_f32 v[34:35], v[34:35], v[210:211]
  v_pk_mul_f32 v[36:37], v[36:37], v[212:213]
  v_pk_mul_f32 v[38:39], v[38:39], v[214:215]
  v_cvt_pk_bf16_f32 v56, v32, v33
  v_cvt_pk_bf16_f32 v57, v34, v35
  v_cvt_pk_bf16_f32 v58, v36, v37
  v_cvt_pk_bf16_f32 v59, v38, v39
  v_lshlrev_b32 v32, 16, v56
  v_and_b32 v33, s23, v56
  v_lshlrev_b32 v34, 16, v57
  v_and_b32 v35, s23, v57
  v_lshlrev_b32 v36, 16, v58
  v_and_b32 v37, s23, v58
  v_lshlrev_b32 v38, 16, v59
  v_and_b32 v39, s23, v59
  v_pk_add_f32 v[32:33], v[32:33], v[40:41]
  v_pk_add_f32 v[34:35], v[34:35], v[42:43]
  v_pk_add_f32 v[36:37], v[36:37], v[44:45]
  v_pk_add_f32 v[38:39], v[38:39], v[46:47]
  v_cvt_pk_bf16_f32 v48, v32, v33
  v_cvt_pk_bf16_f32 v49, v34, v35
  v_cvt_pk_bf16_f32 v50, v36, v37
  v_cvt_pk_bf16_f32 v51, v38, v39
  v_lshlrev_b32 v32, 16, v48
  v_and_b32 v33, s23, v48
  v_lshlrev_b32 v34, 16, v49
  v_and_b32 v35, s23, v49
  v_lshlrev_b32 v36, 16, v50
  v_and_b32 v37, s23, v50
  v_lshlrev_b32 v38, 16, v51
  v_and_b32 v39, s23, v51
  v_pk_add_f32 v[56:57], v[32:33], v[34:35]
  v_pk_mul_f32 v[58:59], v[32:33], v[32:33]
  v_pk_mul_f32 v[60:61], v[32:33], v[240:241]
  v_pk_fma_f32 v[58:59], v[34:35], v[34:35], v[58:59]
  v_pk_fma_f32 v[60:61], v[34:35], v[242:243], v[60:61]
  v_pk_add_f32 v[56:57], v[56:57], v[36:37]
  v_pk_fma_f32 v[58:59], v[36:37], v[36:37], v[58:59]
  v_pk_fma_f32 v[60:61], v[36:37], v[244:245], v[60:61]
  v_pk_add_f32 v[56:57], v[56:57], v[38:39]
  v_pk_fma_f32 v[58:59], v[38:39], v[38:39], v[58:59]
  v_pk_fma_f32 v[60:61], v[38:39], v[246:247], v[60:61]
  v_add_f32 v52, v56, v57
  v_add_f32 v53, v58, v59
  v_add_f32 v54, v60, v61
  s_nop 0
  v_add_f32_dpp v52, v52, v52 row_ror:8 row_mask:0xf bank_mask:0xf
  v_add_f32_dpp v53, v53, v53 row_ror:8 row_mask:0xf bank_mask:0xf
  v_add_f32_dpp v54, v54, v54 row_ror:8 row_mask:0xf bank_mask:0xf
  v_add_f32_dpp v52, v52, v52 row_ror:4 row_mask:0xf bank_mask:0xf
  v_add_f32_dpp v53, v53, v53 row_ror:4 row_mask:0xf bank_mask:0xf
  v_add_f32_dpp v54, v54, v54 row_ror:4 row_mask:0xf bank_mask:0xf
  v_add_f32_dpp v52, v52, v52 row_ror:2 row_mask:0xf bank_mask:0xf
  v_add_f32_dpp v53, v53, v53 row_ror:2 row_mask:0xf bank_mask:0xf
  v_add_f32_dpp v54, v54, v54 row_ror:2 row_mask:0xf bank_mask:0xf
  v_add_f32_dpp v52, v52, v52 row_ror:1 row_mask:0xf bank_mask:0xf
  v_add_f32_dpp v53, v53, v53 row_ror:1 row_mask:0xf bank_mask:0xf
  v_add_f32_dpp v54, v54, v54 row_ror:1 row_mask:0xf bank_mask:0xf
  s_mov_b64 exec, s[24:25]
  buffer_store_dwordx4 v[52:55], v12, s[16:19], s22 offen sc1
  s_mov_b64 exec, -1
  s_mov_b32 s60, 50000
Ls_62:
  s_sleep 8
  buffer_load_dwordx4 v[56:59], v13, s[16:19], s21 offen sc1
  s_waitcnt vmcnt(0)
  v_cmp_ne_u32 vcc, s48, v59
  s_cmp_eq_u64 vcc, 0
  s_cbranch_scc1 Lsd_63
  s_sub_u32 s60, s60, 1
  s_cmp_lg_u32 s60, 0
  s_cbranch_scc1 Ls_62
Lsd_63:
  v_add_f32_dpp v56, v56, v56 quad_perm:[1,0,3,2] row_mask:0xf bank_mask:0xf
  v_add_f32_dpp v57, v57, v57 quad_perm:[1,0,3,2] row_mask:0xf bank_mask:0xf
  v_add_f32_dpp v58, v58, v58 quad_perm:[1,0,3,2] row_mask:0xf bank_mask:0xf
  v_add_f32_dpp v56, v56, v56 quad_perm:[2,3,0,1] row_mask:0xf bank_mask:0xf
  v_add_f32_dpp v57, v57, v57 quad_perm:[2,3,0,1] row_mask:0xf bank_mask:0xf
  v_add_f32_dpp v58, v58, v58 quad_perm:[2,3,0,1] row_mask:0xf bank_mask:0xf
  v_mul_f32 v56, 0x3b000000, v56
  v_mul_f32 v57, 0x3b000000, v57
  v_fma_f32 v57, -v56, v56, v57
  v_max_f32 v57, 0, v57
  v_cvt_pk_bf16_f32 v26, v56, v57
  v_lshlrev_b32 v56, 16, v26
  v_and_b32 v57, 0xffff0000, v26
  v_add_f32 v57, 0x3727c5ac, v57
  v_cvt_pk_bf16_f32 v57, v57, v57
  v_and_b32 v57, 0xffff0000, v57
  v_sqrt_f32 v57, v57
  v_fma_f32 v58, -v56, v252, v58
  v_cvt_pk_bf16_f32 v57, v57, v57
  v_and_b32 v57, 0xffff0000, v57
  v_rcp_f32 v57, v57
  s_nop 0
  v_fma_f32 v58, v58, v57, v253
  v_cvt_pk_bf16_f32 v58, v58, v58
  v_ashrrev_i32 v59, 31, v58
  v_or_b32 v59, 0x80000000, v59
  v_xor_b32 v58, v58, v59
  v_and_b32 v58, 0xffff0000, v58
  v_or_b32 v58, v58, v109
  ds_write_b32 v110, v58
  v_and_b32 v5, 31, v2
  v_lshlrev_b32 v5, 2, v5
  v_add_u32 v5, 65536, v5
  s_waitcnt lgkmcnt(0)
  s_barrier
  ds_read_b32 v10, v5
  v_sub_f32 v40, v32, v56
  v_sub_f32 v41, v33, v56
  v_cvt_pk_bf16_f32 v26, v40, v41
  v_lshlrev_b32 v40, 16, v26
  v_and_b32 v41, 0xffff0000, v26
  v_mul_f32 v40, v40, v57
  v_mul_f32 v41, v41, v57
  v_cvt_pk_bf16_f32 v26, v40, v41
  v_lshlrev_b32 v40, 16, v26
  v_and_b32 v41, 0xffff0000, v26
  v_mul_f32 v40, v40, v224
  v_mul_f32 v41, v41, v225
  v_cvt_pk_bf16_f32 v26, v40, v41
  v_lshlrev_b32 v40, 16, v26
  v_and_b32 v41, 0xffff0000, v26
  v_add_f32 v40, v40, v216
  v_add_f32 v41, v41, v217
  v_cvt_pk_bf16_f32 v60, v40, v41
  s_waitcnt lgkmcnt(0)
  v_mov_b32 v64, v10
  s_nop 1
  v_max_u32_dpp v64, v64, v64 row_ror:8 row_mask:0xf bank_mask:0xf
  s_nop 1
  v_max_u32_dpp v64, v64, v64 row_ror:4 row_mask:0xf bank_mask:0xf
  s_nop 1
  v_max_u32_dpp v64, v64, v64 row_ror:2 row_mask:0xf bank_mask:0xf
  s_nop 1
  v_max_u32_dpp v64, v64, v64 row_ror:1 row_mask:0xf bank_mask:0xf
  s_nop 1
  v_mov_b32 v11, v64
  s_nop 1
  v_permlane16_swap_b32 v11, v64
  s_nop 1
  v_max_u32 v64, v64, v11
  v_mov_b32 v11, v64
  s_nop 1
  v_permlane32_swap_b32 v11, v64
  s_nop 1
  v_max_u32 v64, v64, v11
  v_cmp_eq_u32 vcc, v64, v10
  s_nop 1
  v_cndmask_b32 v65, v10, 0, vcc
  s_nop 1
  v_max_u32_dpp v65, v65, v65 row_ror:8 row_mask:0xf bank_mask:0xf
  s_nop 1
  v_max_u32_dpp v65, v65, v65 row_ror:4 row_mask:0xf bank_mask:0xf
  s_nop 1
  v_max_u32_dpp v65, v65, v65 row_ror:2 row_mask:0xf bank_mask:0xf
  s_nop 1
  v_max_u32_dpp v65, v65, v65 row_ror:1 row_mask:0xf bank_mask:0xf
  s_nop 1
  v_mov_b32 v11, v65
  s_nop 1
  v_permlane16_swap_b32 v11, v65
  s_nop 1
  v_max_u32 v65, v65, v11
  v_mov_b32 v11, v65
  s_nop 1
  v_permlane32_swap_b32 v11, v65
  s_nop 1
  v_max_u32 v65, v65, v11
  v_cmp_eq_u32 s[26:27], v64, v58
  v_cmp_eq_u32 s[28:29], v65, v58
  s_or_b32 s20, s42, s32
  s_cmp_lg_u32 s20, 0
  s_cbranch_scc1 main_notop
  v_and_b32 v65, -2, v65
  v_mov_b32 v66, s48
  v_mov_b32 v67, s48
  s_lshl_b32 s20, s41, 7
  s_add_u32 s20, s20, 393216
  v_mov_b32 v5, 0
  s_mov_b64 exec, 1
  buffer_store_dwordx4 v[64:67], v5, s[16:19], s20 offen sc1
  s_mov_b64 exec, -1
main_notop:
  v_sub_f32 v42, v34, v56
  v_sub_f32 v43, v35, v56
  v_cvt_pk_bf16_f32 v26, v42, v43
  v_lshlrev_b32 v42, 16, v26
  v_and_b32 v43, 0xffff0000, v26
  v_mul_f32 v42, v42, v57
  v_mul_f32 v43, v43, v57
  v_cvt_pk_bf16_f32 v26, v42, v43
  v_lshlrev_b32 v42, 16, v26
  v_and_b32 v43, 0xffff0000, v26
  v_mul_f32 v42, v42, v226
  v_mul_f32 v43, v43, v227
  v_cvt_pk_bf16_f32 v26, v42, v43
  v_lshlrev_b32 v42, 16, v26
  v_and_b32 v43, 0xffff0000, v26
  v_add_f32 v42, v42, v218
  v_add_f32 v43, v43, v219
  v_cvt_pk_bf16_f32 v61, v42, v43
  v_sub_f32 v44, v36, v56
  v_sub_f32 v45, v37, v56
  v_cvt_pk_bf16_f32 v26, v44, v45
  v_lshlrev_b32 v44, 16, v26
  v_and_b32 v45, 0xffff0000, v26
  v_mul_f32 v44, v44, v57
  v_mul_f32 v45, v45, v57
  v_cvt_pk_bf16_f32 v26, v44, v45
  v_lshlrev_b32 v44, 16, v26
  v_and_b32 v45, 0xffff0000, v26
  v_mul_f32 v44, v44, v228
  v_mul_f32 v45, v45, v229
  v_cvt_pk_bf16_f32 v26, v44, v45
  v_lshlrev_b32 v44, 16, v26
  v_and_b32 v45, 0xffff0000, v26
  v_add_f32 v44, v44, v220
  v_add_f32 v45, v45, v221
  v_cvt_pk_bf16_f32 v62, v44, v45
  v_sub_f32 v46, v38, v56
  v_sub_f32 v47, v39, v56
  v_cvt_pk_bf16_f32 v26, v46, v47
  v_lshlrev_b32 v46, 16, v26
  v_and_b32 v47, 0xffff0000, v26
  v_mul_f32 v46, v46, v57
  v_mul_f32 v47, v47, v57
  v_cvt_pk_bf16_f32 v26, v46, v47
  v_lshlrev_b32 v46, 16, v26
  v_and_b32 v47, 0xffff0000, v26
  v_mul_f32 v46, v46, v230
  v_mul_f32 v47, v47, v231
  v_cvt_pk_bf16_f32 v26, v46, v47
  v_lshlrev_b32 v46, 16, v26
  v_and_b32 v47, 0xffff0000, v26
  v_add_f32 v46, v46, v222
  v_add_f32 v47, v47, v223
  v_cvt_pk_bf16_f32 v63, v46, v47
  s_or_b64 s[62:63], s[26:27], s[28:29]
  s_cmp_eq_u64 s[62:63], 0
  s_cbranch_scc1 main_nocand
  v_mov_b32 v5, 2048
  v_cndmask_b32 v5, 0, v5, s[28:29]
  v_lshl_add_u32 v5, v8, 4, v5
  s_lshl_b32 s20, s41, 12
  s_lshl_b32 s21, s42, 8
  s_add_u32 s20, s20, s21
  s_add_u32 s20, s20, 524288
  s_mov_b64 exec, s[62:63]
  buffer_store_dwordx4 v[60:63], v5, s[16:19], s20 offen sc1
  buffer_store_dwordx4 v[48:51], v5, s[16:19], s20 offen offset:1024 sc1
  s_mov_b64 exec, -1
main_nocand:
  s_cmp_lg_u32 s32, 0
  s_cbranch_scc1 main_notp
  s_mov_b32 s22, 393216
  v_lshlrev_b32 v76, 7, v2
  buffer_load_dwordx4 v[68:71], v76, s[16:19], s22 offen sc1
main_notp:
  v_lshlrev_b32 v40, 16, v60
  v_and_b32 v41, 0xffff0000, v60
  v_mul_f32 v40, v40, v232
  v_mul_f32 v41, v41, v233
  v_cvt_pk_bf16_f32 v26, v40, v41
  v_lshlrev_b32 v40, 16, v26
  v_and_b32 v41, 0xffff0000, v26
  v_add_f32 v40, v40, v32
  v_add_f32 v41, v41, v33
  v_cvt_pk_bf16_f32 v72, v40, v41
  v_lshlrev_b32 v42, 16, v61
  v_and_b32 v43, 0xffff0000, v61
  v_mul_f32 v42, v42, v234
  v_mul_f32 v43, v43, v235
  v_cvt_pk_bf16_f32 v26, v42, v43
  v_lshlrev_b32 v42, 16, v26
  v_and_b32 v43, 0xffff0000, v26
  v_add_f32 v42, v42, v34
  v_add_f32 v43, v43, v35
  v_cvt_pk_bf16_f32 v73, v42, v43
  v_lshlrev_b32 v44, 16, v62
  v_and_b32 v45, 0xffff0000, v62
  v_mul_f32 v44, v44, v236
  v_mul_f32 v45, v45, v237
  v_cvt_pk_bf16_f32 v26, v44, v45
  v_lshlrev_b32 v44, 16, v26
  v_and_b32 v45, 0xffff0000, v26
  v_add_f32 v44, v44, v36
  v_add_f32 v45, v45, v37
  v_cvt_pk_bf16_f32 v74, v44, v45
  v_lshlrev_b32 v46, 16, v63
  v_and_b32 v47, 0xffff0000, v63
  v_mul_f32 v46, v46, v238
  v_mul_f32 v47, v47, v239
  v_cvt_pk_bf16_f32 v26, v46, v47
  v_lshlrev_b32 v46, 16, v26
  v_and_b32 v47, 0xffff0000, v26
  v_add_f32 v46, v46, v38
  v_add_f32 v47, v47, v39
  v_cvt_pk_bf16_f32 v75, v46, v47
  s_cmp_lg_u32 s32, 0
  s_cbranch_scc1 main_w0e
  s_mov_b32 s60, 50000
  s_branch Ltw_67
Lt_65:
  s_cmp_lt_u32 s2, 144
  s_cbranch_scc1 Lsl_68
  s_sleep 40
Lsl_68:
  buffer_load_dwordx4 v[68:71], v76, s[16:19], s22 offen sc1
Ltw_67:
  s_waitcnt vmcnt(0)
  v_cmp_ne_u32 vcc, s48, v70
  s_cmp_eq_u64 vcc, 0
  s_cbranch_scc1 Ltd_66
  s_sub_u32 s60, s60, 1
  s_sleep 2
  s_cmp_lg_u32 s60, 0
  s_cbranch_scc1 Lt_65
Ltd_66:
  v_mov_b32 v64, v68
  s_nop 1
  v_max_u32_dpp v64, v64, v64 row_ror:8 row_mask:0xf bank_mask:0xf
  s_nop 1
  v_max_u32_dpp v64, v64, v64 row_ror:4 row_mask:0xf bank_mask:0xf
  s_nop 1
  v_max_u32_dpp v64, v64, v64 row_ror:2 row_mask:0xf bank_mask:0xf
  s_nop 1
  v_max_u32_dpp v64, v64, v64 row_ror:1 row_mask:0xf bank_mask:0xf
  s_nop 1
  v_mov_b32 v11, v64
  s_nop 1
  v_permlane16_swap_b32 v11, v64
  s_nop 1
  v_max_u32 v64, v64, v11
  v_mov_b32 v11, v64
  s_nop 1
  v_permlane32_swap_b32 v11, v64
  s_nop 1
  v_max_u32 v64, v64, v11
  v_cmp_eq_u32 vcc, v64, v68
  s_nop 1
  v_cndmask_b32 v65, v68, v69, vcc
  s_nop 1
  v_max_u32_dpp v65, v65, v65 row_ror:8 row_mask:0xf bank_mask:0xf
  s_nop 1
  v_max_u32_dpp v65, v65, v65 row_ror:4 row_mask:0xf bank_mask:0xf
  s_nop 1
  v_max_u32_dpp v65, v65, v65 row_ror:2 row_mask:0xf bank_mask:0xf
  s_nop 1
  v_max_u32_dpp v65, v65, v65 row_ror:1 row_mask:0xf bank_mask:0xf
  s_nop 1
  v_mov_b32 v11, v65
  s_nop 1
  v_permlane16_swap_b32 v11, v65
  s_nop 1
  v_max_u32 v65, v65, v11
  v_mov_b32 v11, v65
  s_nop 1
  v_permlane32_swap_b32 v11, v65
  s_nop 1
  v_max_u32 v65, v65, v11
  v_mov_b32 v5, 65792
  ds_write_b64 v5, v[64:65]
  s_waitcnt lgkmcnt(0)
main_w0e:
  s_andn2_b64 exec, -1, s[62:63]
  global_store_dwordx4 v111, v[72:75], s[50:51]
  s_mov_b64 exec, -1
  s_barrier
  v_mov_b32 v5, 65792
  ds_read_b64 v[64:65], v5
  s_waitcnt lgkmcnt(0)
  s_cmp_eq_u64 s[62:63], 0
  s_cbranch_scc1 main_nodef
  v_or_b32 v5, 1, v64
  v_or_b32 v6, 1, v65
  v_cmp_ne_u32 vcc, v5, v58
  v_cmp_ne_u32 s[20:21], v6, v58
  s_and_b64 vcc, vcc, s[20:21]
  s_and_b64 exec, vcc, s[62:63]
  s_cbranch_execz main_nodef
  global_store_dwordx4 v111, v[72:75], s[50:51]
main_nodef:
  s_mov_b64 exec, -1
  s_cmp_ge_u32 s2, 144
  s_cbranch_scc1 main_done
  s_cmp_ge_u32 s2, 112
  s_cbranch_scc1 main_down
  v_and_b32 v15, 1, v2
  v_cmp_eq_u32 vcc, 0, v15
  s_lshr_b32 s21, s32, 1
  s_lshl_b32 s21, s21, 8
  v_cndmask_b32 v16, v65, v64, vcc
  v_bfe_u32 v17, v16, 6, 6
  v_sub_u32 v17, 63, v17
  v_lshlrev_b32 v17, 12, v17
  v_not_b32 v18, v16
  v_and_b32 v18, 1, v18
  v_lshl_add_u32 v17, v18, 11, v17
  v_lshrrev_b32 v18, 4, v2
  v_lshl_add_u32 v17, v18, 4, v17
  s_add_u32 s22, s21, 524288
  s_mov_b32 s60, 50000
Lh_69:
  buffer_load_dwordx4 v[32:35], v17, s[16:19], s22 offen offset:0 sc1
  buffer_load_dwordx4 v[36:39], v17, s[16:19], s22 offen offset:64 sc1
  buffer_load_dwordx4 v[40:43], v17, s[16:19], s22 offen offset:128 sc1
  buffer_load_dwordx4 v[44:47], v17, s[16:19], s22 offen offset:192 sc1
  s_waitcnt vmcnt(0)
  v_max3_u32 v5, v32, v36, v40
  v_max_u32 v5, v5, v44
  v_cmp_eq_u32 vcc, -1, v5
  s_cmp_eq_u64 vcc, 0
  s_cbranch_scc1 Lhd_70
  s_sub_u32 s60, s60, 1
  s_sleep 2
  s_cmp_lg_u32 s60, 0
  s_cbranch_scc1 Lh_69
Lhd_70:
  v_mfma_f32_16x16x32_bf16 v[20:23], v[32:35], v[176:179], 0
  v_mfma_f32_16x16x32_bf16 v[20:23], v[36:39], v[180:183], v[20:23]
  v_mfma_f32_16x16x32_bf16 v[20:23], v[40:43], v[184:187], v[20:23]
  v_mfma_f32_16x16x32_bf16 v[20:23], v[44:47], v[188:191], v[20:23]
  s_lshl_b32 s23, s32, 7
  s_add_u32 s23, s23, 66560
  v_lshl_add_u32 v24, v2, 2, s23
  s_mov_b64 exec, 0xffff
  s_nop 4
  ds_write_b32 v24, v20
  ds_write_b32 v24, v21 offset:64
  s_mov_b64 exec, -1
  s_waitcnt lgkmcnt(0)
  s_barrier
  s_cmp_lg_u32 s32, 0
  s_cbranch_scc1 main_done
  v_and_b32 v24, 31, v0
  v_lshlrev_b32 v24, 2, v24
  v_add_u32 v24, 66560, v24
  ds_read_b32 v32, v24 offset:0
  ds_read_b32 v33, v24 offset:128
  ds_read_b32 v34, v24 offset:256
  ds_read_b32 v35, v24 offset:384
  ds_read_b32 v36, v24 offset:512
  ds_read_b32 v37, v24 offset:640
  ds_read_b32 v38, v24 offset:768
  ds_read_b32 v39, v24 offset:896
  v_lshlrev_b32 v25, 1, v0
  s_lshl_b32 s21, s33, 7
  s_add_u32 s21, s21, 409600
  s_waitcnt lgkmcnt(0)
  v_add_f32 v32, v32, v34
  v_add_f32 v33, v33, v35
  v_add_f32 v32, v32, v36
  v_add_f32 v33, v33, v37
  v_add_f32 v32, v32, v38
  v_add_f32 v33, v33, v39
  v_cvt_pk_bf16_f32 v40, v32, v33
  v_lshlrev_b32 v32, 16, v40
  v_and_b32 v33, 0xffff0000, v40
  v_mul_f32 v34, 0xbfb8aa3b, v32
  v_exp_f32 v34, v34
  s_nop 0
  v_add_f32 v34, 1.0, v34
  v_rcp_f32 v34, v34
  s_nop 0
  v_mul_f32 v32, v32, v34
  v_cvt_pk_bf16_f32 v32, v32, v32
  v_and_b32 v32, 0xffff0000, v32
  v_mul_f32 v32, v32, v33
  s_nop 1
  v_mov_b32_dpp v33, v32 quad_perm:[1,0,3,2] row_mask:0xf bank_mask:0xf
  v_cvt_pk_bf16_f32 v32, v32, v33
  s_mov_b64 exec, 0x55555555
  buffer_store_dword v32, v25, s[16:19], s21 offen sc1
  s_mov_b64 exec, -1
  s_branch main_done
main_down:
  v_bfe_u32 v15, v0, 4, 1
  v_cmp_eq_u32 vcc, 0, v15
  s_lshl_b32 s21, s33, 5
  s_add_u32 s22, s21, 524288
  v_cndmask_b32 v12, v65, v64, vcc
  v_bfe_u32 v16, v12, 6, 6
  v_sub_u32 v16, 63, v16
  v_lshlrev_b32 v16, 12, v16
  v_not_b32 v17, v12
  v_and_b32 v17, 1, v17
  v_lshl_add_u32 v16, v17, 11, v16
  v_and_b32 v17, 14, v8
  v_lshl_add_u32 v16, v17, 1, v16
  s_lshr_b32 s23, s33, 4
  s_lshl_b32 s23, s23, 12
  s_and_b32 s20, s33, 15
  s_lshl_b32 s20, s20, 6
  s_add_u32 s23, s23, s20
  s_add_u32 s23, s23, 155648
  v_lshl_add_u32 v19, v8, 2, s23
  ds_read_b32 v19, v19
  s_mov_b32 s60, 50000
Lf_72:
  buffer_load_dword v17, v16, s[16:19], s22 offen sc1
  buffer_load_dword v18, v16, s[16:19], s22 offen offset:1024 sc1
  s_waitcnt vmcnt(0)
  v_max_u32 v5, v17, v18
  v_cmp_eq_u32 vcc, -1, v5
  s_cmp_eq_u64 vcc, 0
  s_cbranch_scc1 Lfd_73
  s_sub_u32 s60, s60, 1
  s_sleep 2
  s_cmp_lg_u32 s60, 0
  s_cbranch_scc1 Lf_72
Lfd_73:
  v_bfe_u32 v15, v12, 1, 11
  v_sub_u32 v15, 2047, v15
  v_lshlrev_b32 v15, 10, v15
  v_lshl_add_u32 v15, v8, 1, v15
  v_add_u32 v15, s21, v15
  v_and_b32 v16, 1, v0
  v_lshlrev_b32 v16, 4, v16
  v_lshrrev_b32 v17, v16, v17
  v_lshrrev_b32 v18, v16, v18
  v_lshlrev_b32 v17, 16, v17
  v_lshlrev_b32 v18, 16, v18
  v_and_b32 v12, 0xffff0000, v12
  v_ashrrev_i32 v25, 31, v12
  v_not_b32 v25, v25
  v_or_b32 v25, 0x80000000, v25
  v_xor_b32 v12, v12, v25
  v_and_b32 v12, 0xffff0000, v12
  v_mul_f32 v25, 0xbfb8aa3b, v12
  v_exp_f32 v25, v25
  s_nop 0
  v_add_f32 v25, 1.0, v25
  v_rcp_f32 v25, v25
  s_nop 0
  v_cvt_pk_bf16_f32 v25, v25, v25
  v_and_b32 v25, 0xffff0000, v25
  v_and_b32 v13, 1, v2
  v_lshlrev_b32 v13, 5, v13
  v_bfe_u32 v14, v2, 4, 1
  v_lshl_add_u32 v13, v14, 4, v13
  v_lshrrev_b32 v14, 5, v2
  v_lshl_add_u32 v13, v14, 7, v13
  s_mul_i32 s22, s32, 1792
  s_add_u32 s22, s22, 409600
  s_mov_b32 s60, 50000
La_75:
  buffer_load_dwordx4 v[32:35], v13, s[16:19], s22 offen offset:0 sc1
  buffer_load_dwordx4 v[36:39], v13, s[16:19], s22 offen offset:256 sc1
  buffer_load_dwordx4 v[40:43], v13, s[16:19], s22 offen offset:512 sc1
  buffer_load_dwordx4 v[44:47], v13, s[16:19], s22 offen offset:768 sc1
  buffer_load_dwordx4 v[48:51], v13, s[16:19], s22 offen offset:1024 sc1
  buffer_load_dwordx4 v[52:55], v13, s[16:19], s22 offen offset:1280 sc1
  buffer_load_dwordx4 v[56:59], v13, s[16:19], s22 offen offset:1536 sc1
  s_waitcnt vmcnt(0)
  v_max3_u32 v5, v32, v33, v34
  v_max3_u32 v5, v5, v35, v36
  v_max3_u32 v5, v5, v37, v38
  v_max3_u32 v5, v5, v39, v40
  v_max3_u32 v5, v5, v41, v42
  v_max3_u32 v5, v5, v43, v44
  v_max3_u32 v5, v5, v45, v46
  v_max3_u32 v5, v5, v47, v48
  v_max3_u32 v5, v5, v49, v50
  v_max3_u32 v5, v5, v51, v52
  v_max3_u32 v5, v5, v53, v54
  v_max3_u32 v5, v5, v55, v56
  v_max3_u32 v5, v5, v57, v58
  v_max_u32 v5, v5, v59
  v_cmp_eq_u32 vcc, -1, v5
  s_cmp_eq_u64 vcc, 0
  s_cbranch_scc1 Lad_76
  s_sub_u32 s60, s60, 1
  s_sleep 2
  s_cmp_lg_u32 s60, 0
  s_cbranch_scc1 La_75
Lad_76:
  v_mfma_f32_16x16x32_bf16 v[20:23], v[32:35], v[176:179], 0
  v_mfma_f32_16x16x32_bf16 v[20:23], v[36:39], v[180:183], v[20:23]
  v_mfma_f32_16x16x32_bf16 v[20:23], v[40:43], v[184:187], v[20:23]
  v_mfma_f32_16x16x32_bf16 v[20:23], v[44:47], v[188:191], v[20:23]
  v_mfma_f32_16x16x32_bf16 v[20:23], v[48:51], v[192:195], v[20:23]
  v_mfma_f32_16x16x32_bf16 v[20:23], v[52:55], v[196:199], v[20:23]
  v_mfma_f32_16x16x32_bf16 v[20:23], v[56:59], v[200:203], v[20:23]
  s_lshl_b32 s23, s32, 7
  s_add_u32 s23, s23, 66560
  v_lshl_add_u32 v24, v2, 2, s23
  s_mov_b64 exec, 0xffff
  s_nop 4
  ds_write_b32 v24, v20
  ds_write_b32 v24, v21 offset:64
  s_mov_b64 exec, -1
  s_waitcnt lgkmcnt(0)
  s_barrier
  s_cmp_lg_u32 s32, 0
  s_cbranch_scc1 main_done
  v_and_b32 v24, 31, v0
  v_lshlrev_b32 v24, 2, v24
  v_add_u32 v24, 66560, v24
  ds_read_b32 v32, v24 offset:0
  ds_read_b32 v33, v24 offset:128
  ds_read_b32 v34, v24 offset:256
  ds_read_b32 v35, v24 offset:384
  ds_read_b32 v36, v24 offset:512
  ds_read_b32 v37, v24 offset:640
  ds_read_b32 v38, v24 offset:768
  ds_read_b32 v39, v24 offset:896
  s_waitcnt lgkmcnt(0)
  v_add_f32 v32, v32, v33
  v_add_f32 v32, v32, v34
  v_add_f32 v32, v32, v35
  v_add_f32 v32, v32, v36
  v_add_f32 v32, v32, v37
  v_add_f32 v32, v32, v38
  v_add_f32 v32, v32, v39
  v_cvt_pk_bf16_f32 v32, v32, v32
  v_and_b32 v32, 0xffff0000, v32
  v_mul_f32 v32, v32, v25
  v_cvt_pk_bf16_f32 v32, v32, v32
  v_and_b32 v32, 0xffff0000, v32
  v_add_f32 v32, v32, v17
  v_cvt_pk_bf16_f32 v32, v32, v32
  v_and_b32 v32, 0xffff0000, v32
  v_mul_f32 v32, v32, v19
  v_cvt_pk_bf16_f32 v32, v32, v32
  v_and_b32 v32, 0xffff0000, v32
  v_add_f32 v32, v32, v18
  v_cvt_pk_bf16_f32 v32, v32, v32
  s_mov_b32 exec_hi, 0
  global_store_short v15, v32, s[50:51]
  s_cmp_lg_u32 s33, 0
  s_cbranch_scc1 main_done
  v_mov_b32 v5, 0
  v_mov_b32 v6, s48
  s_mov_b64 exec, 1
  global_store_dword v5, v6, s[4:5]
main_done:
main_end:
  s_endpgm
main_fallback:
  s_mov_b32 s37, 1
  s_mov_b32 s20, 64
  v_mov_b32 v6, 0xff800000
  v_mov_b32 v5, v3
main_fb_loop:
  ds_read_b128 v[84:87], v5
  v_add_u32 v5, 0x800, v5
  s_waitcnt lgkmcnt(0)
  v_mfma_f32_32x32x16_bf16 v[36:51], v[84:87], v[16:19], 0
  s_nop 11
  v_max3_f32 v6, v6, v36, v37
  v_max3_f32 v6, v6, v38, v39
  v_max3_f32 v6, v6, v40, v41
  v_max3_f32 v6, v6, v42, v43
  v_max3_f32 v6, v6, v44, v45
  v_max3_f32 v6, v6, v46, v47
  v_max3_f32 v6, v6, v48, v49
  v_max3_f32 v6, v6, v50, v51
  s_sub_u32 s20, s20, 1
  s_cmp_lg_u32 s20, 0
  s_cbranch_scc1 main_fb_loop
  ds_read_b128 v[84:87], v3
  ds_read_b128 v[88:91], v3 offset:2048
  v_mov_b32 v68, 0
  v_mov_b32 v69, 0
  v_mov_b32 v70, 0
  v_mov_b32 v71, 0
  v_mov_b32 v72, 0
  v_mov_b32 v73, 0
  v_mov_b32 v74, 0
  v_mov_b32 v75, 0
  v_mov_b32 v76, 0
  v_mov_b32 v77, 0
  v_mov_b32 v78, 0
  v_mov_b32 v79, 0
  v_mov_b32 v80, 0
  v_mov_b32 v81, 0
  v_mov_b32 v82, 0
  v_mov_b32 v83, 0
  v_mov_b32 v7, v6
  s_nop 1
  v_permlane32_swap_b32 v7, v6
  s_nop 1
  v_max_f32 v6, v6, v7
  v_sub_f32 v20, 0, v6
  v_sub_f32 v21, 0, v6
  v_sub_f32 v22, 0, v6
  v_sub_f32 v23, 0, v6
  v_sub_f32 v24, 0, v6
  v_sub_f32 v25, 0, v6
  v_sub_f32 v26, 0, v6
  v_sub_f32 v27, 0, v6
  v_sub_f32 v28, 0, v6
  v_sub_f32 v29, 0, v6
  v_sub_f32 v30, 0, v6
  v_sub_f32 v31, 0, v6
  v_sub_f32 v32, 0, v6
  v_sub_f32 v33, 0, v6
  v_sub_f32 v34, 0, v6
  v_sub_f32 v35, 0, v6
  s_mov_b64 exec, s[38:39]
  ds_read_b128 v[92:95], v4
  ds_read_b128 v[96:99], v4 offset:512
  s_mov_b64 exec, -1
  s_waitcnt lgkmcnt(0)
  v_mfma_f32_32x32x16_bf16 v[36:51], v[84:87], v[16:19], v[20:35]
  v_mov_b32 v60, 0
  v_mov_b32 v61, 0
  v_mov_b32 v62, 0
  v_mov_b32 v63, 0
  v_mov_b32 v64, 0
  v_mov_b32 v65, 0
  v_mov_b32 v66, 0
  v_mov_b32 v67, 0
  s_mov_b32 s20, 32
  s_nop 3
main_fb2:
  s_waitcnt lgkmcnt(0)
  v_exp_f32 v36, v36
  v_exp_f32 v37, v37
  v_exp_f32 v38, v38
  v_smfmac_f32_32x32x32_bf16 v[68:83], v[104:107], v[60:67], v108
  v_exp_f32 v39, v39
  v_exp_f32 v40, v40
  v_exp_f32 v41, v41
  v_exp_f32 v42, v42
  v_mfma_f32_32x32x16_bf16 v[52:67], v[88:91], v[16:19], v[20:35]
  ds_read_b128 v[84:87], v3 offset:4096
  s_mov_b64 exec, s[38:39]
  ds_read_b128 v[100:103], v4 offset:2048
  ds_read_b128 v[104:107], v4 offset:2560
  s_mov_b64 exec, -1
  v_exp_f32 v43, v43
  v_exp_f32 v44, v44
  v_exp_f32 v45, v45
  v_exp_f32 v46, v46
  v_exp_f32 v47, v47
  v_smfmac_f32_32x32x32_bf16 v[68:83], v[92:95], v[36:43], v108
  v_exp_f32 v48, v48
  v_exp_f32 v49, v49
  v_exp_f32 v50, v50
  v_exp_f32 v51, v51
  s_waitcnt lgkmcnt(0)
  v_exp_f32 v52, v52
  v_exp_f32 v53, v53
  v_exp_f32 v54, v54
  v_smfmac_f32_32x32x32_bf16 v[68:83], v[96:99], v[44:51], v108
  v_exp_f32 v55, v55
  v_exp_f32 v56, v56
  v_exp_f32 v57, v57
  v_exp_f32 v58, v58
  v_mfma_f32_32x32x16_bf16 v[36:51], v[84:87], v[16:19], v[20:35]
  ds_read_b128 v[88:91], v3 offset:6144
  s_mov_b64 exec, s[38:39]
  ds_read_b128 v[92:95], v4 offset:4096
  ds_read_b128 v[96:99], v4 offset:4608
  s_mov_b64 exec, -1
  v_exp_f32 v59, v59
  v_exp_f32 v60, v60
  v_exp_f32 v61, v61
  v_exp_f32 v62, v62
  v_exp_f32 v63, v63
  v_smfmac_f32_32x32x32_bf16 v[68:83], v[100:103], v[52:59], v108
  v_exp_f32 v64, v64
  v_exp_f32 v65, v65
  v_exp_f32 v66, v66
  v_exp_f32 v67, v67
  v_add_u32 v3, 0x1000, v3
  v_add_u32 v4, 0x1000, v4
  s_sub_u32 s20, s20, 1
  s_cmp_lg_u32 s20, 0
  s_cbranch_scc1 main_fb2
  v_subrev_u32 v3, 0x20000, v3
  v_subrev_u32 v4, 0x20000, v4
  s_branch main_attn_tail
.section .rodata,"a"
.p2align 6
.amdhsa_kernel adaLN_cond__mha_block__moe_arch_mod__prompt_kernel
  .amdhsa_next_free_vgpr 256
  .amdhsa_next_free_sgpr 102
  .amdhsa_accum_offset 256
  .amdhsa_group_segment_fixed_size 0
  .amdhsa_kernarg_size 104
  .amdhsa_user_sgpr_count 2
  .amdhsa_user_sgpr_kernarg_segment_ptr 1
  .amdhsa_system_sgpr_workgroup_id_x 1
.end_amdhsa_kernel
```
